```python
import torch

def _softmax(x, axis=-1):
    return torch.softmax(x, dim=axis)
def _gelu(x):
    return torch.nn.functional.gelu(x, approximate="tanh")
def _silu(x):
    return torch.nn.functional.silu(x)
def _sigmoid(x):
    return torch.sigmoid(x)
def _layernorm(x, axis=-1, eps=1e-5):
    m = x.mean(dim=axis, keepdim=True)
    v = x.var(dim=axis, keepdim=True, unbiased=False)
    return (x - m) / torch.sqrt(v + eps)
def _scatter_add(tgt, idx, src, axis=0):
    return tgt.clone().index_add_(axis, idx, src)
def _segment_sum(src, seg, n):
    out = torch.zeros((n,) + src.shape[1:], dtype=src.dtype)
    return out.index_add_(0, seg, src)
def _pad(x, pw):
    flat = tuple(v for pair in reversed(pw) for v in pair)
    return torch.nn.functional.pad(x, flat)

kernel_name = 'gated_mix__gqa_block_cached__gqa_block_cached__decode'

def setup_inputs():

    _w = (lambda a: (lambda t: t.to(torch.bfloat16) if t.is_floating_point() else t)(torch.as_tensor(a)))
    def _A_setup():
        B, Sq, D = 2, 1, 448
        Hq, Hkv, Sk, Dh = 16, 8, 8192, 256
        assert Hq % Hkv == 0, (Hq, Hkv)
        return {
            "x": _w((lambda *s: torch.randn(*s, dtype=torch.bfloat16) * 0.05)(B, Sq, D)),
            "k_cache": _w((lambda *s: torch.randn(*s, dtype=torch.bfloat16) * 6.4)(B, Hkv, Sk, Dh)),
            "v_cache": _w((lambda *s: torch.randn(*s, dtype=torch.bfloat16) * 0.05)(B, Hkv, Sk, Dh)),
            "wq": _w((lambda *s: torch.randn(*s, dtype=torch.bfloat16) * 6.4)(D, Hq * Dh) * (D ** -0.5)),
            "wo": _w((lambda *s: torch.randn(*s, dtype=torch.bfloat16) * 0.05)(Hq * Dh, D) * ((Hq * Dh) ** -0.5)),
        }
    _A_in = _A_setup()

    def _B_setup():
        B, Sq, D = 2, 1, 448
        Hq, Hkv, Sk, Dh = 16, 8, 8192, 256
        assert Hq % Hkv == 0, (Hq, Hkv)
        return {
            "x": _w((lambda *s: torch.randn(*s, dtype=torch.bfloat16) * 0.05)(B, Sq, D)),
            "k_cache": _w((lambda *s: torch.randn(*s, dtype=torch.bfloat16) * 6.4)(B, Hkv, Sk, Dh)),
            "v_cache": _w((lambda *s: torch.randn(*s, dtype=torch.bfloat16) * 0.05)(B, Hkv, Sk, Dh)),
            "wq": _w((lambda *s: torch.randn(*s, dtype=torch.bfloat16) * 6.4)(D, Hq * Dh) * (D ** -0.5)),
            "wo": _w((lambda *s: torch.randn(*s, dtype=torch.bfloat16) * 0.05)(Hq * Dh, D) * ((Hq * Dh) ** -0.5)),
        }
    _B_in = _B_setup()

    return {
        "A_x": _A_in["x"],
        "A_k_cache": _A_in["k_cache"],
        "A_v_cache": _A_in["v_cache"],
        "A_wq": _A_in["wq"],
        "A_wo": _A_in["wo"],
        "B_x": _B_in["x"],
        "B_k_cache": _B_in["k_cache"],
        "B_v_cache": _B_in["v_cache"],
        "B_wq": _B_in["wq"],
        "B_wo": _B_in["wo"],
        "gate_w": _w((lambda *s: torch.randn(*s, dtype=torch.bfloat16) * 0.05)(448) * 16.0),
    }

def reference(A_x, A_k_cache, A_v_cache, A_wq, A_wo, B_x, B_k_cache, B_v_cache, B_wq, B_wo, gate_w):
    def _A_ref(x, k_cache, v_cache, wq, wo):
        B, Sq, D = x.shape
        Hq, Dh = 16, 256
        Hkv = k_cache.shape[1]
        rep = Hq // Hkv
        q = (lambda x, *d: x.permute(*d))((x @ wq).reshape(B, Sq, Hq, Dh), 0, 2, 1, 3)
        k = (lambda x, n, axis: torch.repeat_interleave(x, n, dim=axis))(k_cache, rep, axis=1)
        v = (lambda x, n, axis: torch.repeat_interleave(x, n, dim=axis))(v_cache, rep, axis=1)
        scores = torch.einsum("bhqd,bhkd->bhqk", q, k) * (Dh ** -0.5)
        p = _softmax(scores, axis=-1)
        o = torch.einsum("bhqk,bhkd->bhqd", p, v)
        return (lambda x, *d: x.permute(*d))(o, 0, 2, 1, 3).reshape(B, Sq, Hq * Dh) @ wo

    def _B_ref(x, k_cache, v_cache, wq, wo):
        B, Sq, D = x.shape
        Hq, Dh = 16, 256
        Hkv = k_cache.shape[1]
        rep = Hq // Hkv
        q = (lambda x, *d: x.permute(*d))((x @ wq).reshape(B, Sq, Hq, Dh), 0, 2, 1, 3)
        k = (lambda x, n, axis: torch.repeat_interleave(x, n, dim=axis))(k_cache, rep, axis=1)
        v = (lambda x, n, axis: torch.repeat_interleave(x, n, dim=axis))(v_cache, rep, axis=1)
        scores = torch.einsum("bhqd,bhkd->bhqk", q, k) * (Dh ** -0.5)
        p = _softmax(scores, axis=-1)
        o = torch.einsum("bhqk,bhkd->bhqd", p, v)
        return (lambda x, *d: x.permute(*d))(o, 0, 2, 1, 3).reshape(B, Sq, Hq * Dh) @ wo

    x = A_x
    g = _sigmoid((x * gate_w).sum(-1, keepdims=True))
    a = _A_ref(x, A_k_cache, A_v_cache, A_wq, A_wo)
    b = _B_ref(x, B_k_cache, B_v_cache, B_wq, B_wo)
    return g * a + (1 - g) * b
```

```asm
; @launch grid=(256,1,1) block=(320,1,1) lds=163840
.amdgcn_target "amdgcn-amd-amdhsa--gfx950"
.text
.globl gated_mix__gqa_block_cached__gqa_block_cached__decode_kernel
.p2align 8
.type gated_mix__gqa_block_cached__gqa_block_cached__decode_kernel,@function
gated_mix__gqa_block_cached__gqa_block_cached__decode_kernel:
  s_cmp_ge_u32 s2, 256
  s_cbranch_scc1 L_end
  s_and_b32 s66, s2, 7
  s_lshr_b32 s67, s2, 3
  s_lshr_b32 s6, s66, 2
  s_mul_i32 s68, s6, 40
  s_add_u32 s68, s68, 8
  s_load_dwordx8 s[8:15], s[0:1], s68
  s_load_dwordx8 s[16:23], s[0:1], 80
  s_load_dwordx2 s[24:25], s[0:1], 0
  s_and_b32 s69, s67, 1
  s_lshl_b32 s4, s66, 1
  s_add_u32 s4, s4, s69
  s_lshr_b32 s5, s67, 1
  s_and_b32 s7, s4, 7
  s_lshr_b32 s26, s5, 3
  s_and_b32 s27, s5, 7
  v_lshrrev_b32 v4, 6, v0
  v_and_b32 v1, 63, v0
  v_readfirstlane_b32 s3, v4
  v_and_b32 v2, 15, v1
  v_lshrrev_b32 v3, 4, v1
  s_and_b32 s73, s5, 1
  s_lshr_b32 s74, s5, 1
  v_lshrrev_b32 v4, 3, v1
  v_and_b32 v5, 7, v1
  v_lshrrev_b32 v6, 4, v1
  v_lshlrev_b32 v6, 1, v6
  v_xor_b32 v5, v5, v6
  v_lshlrev_b32 v5, 4, v5
  s_cmp_eq_u32 s3, 4
  s_cbranch_scc1 L_helper
  s_movk_i32 s66, 896
  v_mad_u32_u24 v29, v4, s66, v5
  v_lshrrev_b32 v4, 5, v1
  v_and_b32 v5, 31, v1
  v_add_u32 v6, 0, v4
  v_lshlrev_b32 v6, 1, v6
  v_xor_b32 v6, v6, v5
  v_lshlrev_b32 v6, 4, v6
  v_lshl_add_u32 v12, v4, 9, v6
  v_add_u32 v6, 2, v4
  v_lshlrev_b32 v6, 1, v6
  v_xor_b32 v6, v6, v5
  v_lshlrev_b32 v6, 4, v6
  v_lshl_add_u32 v13, v4, 9, v6
  v_add_u32 v6, 4, v4
  v_lshlrev_b32 v6, 1, v6
  v_xor_b32 v6, v6, v5
  v_lshlrev_b32 v6, 4, v6
  v_lshl_add_u32 v14, v4, 9, v6
  v_add_u32 v6, 6, v4
  v_lshlrev_b32 v6, 1, v6
  v_xor_b32 v6, v6, v5
  v_lshlrev_b32 v6, 4, v6
  v_lshl_add_u32 v15, v4, 9, v6
  v_lshrrev_b32 v4, 2, v1
  v_and_b32 v5, 3, v1
  v_lshrrev_b32 v6, 5, v1
  v_lshlrev_b32 v6, 1, v6
  v_xor_b32 v5, v5, v6
  v_lshlrev_b32 v5, 4, v5
  v_lshl_add_u32 v28, v4, 13, v5
  s_lshl_b32 s56, s7, 10
  s_lshl_b32 s57, s5, 6
  s_add_u32 s56, s56, s57
  s_mul_i32 s57, s3, 917504
  s_add_u32 s56, s56, s57
  s_mul_i32 s57, s3, 7168
  s_add_u32 s57, s57, 131072
  s_lshl_b32 s64, s3, 15
  s_lshl_b32 s66, s2, 2
  s_add_u32 s66, s66, s3
  s_mul_i32 s66, s66, 5
  s_and_b32 s66, s66, 31
  s_lshl_b32 s65, s66, 12
  s_lshl_b32 s66, s26, 3
  s_add_u32 s66, s66, s7
  s_lshl_b32 s66, s66, 22
  s_lshl_b32 s67, s27, 19
  s_add_u32 s66, s66, s67
  s_lshl_b32 s67, s3, 17
  s_add_u32 s66, s66, s67
  s_lshl_b32 s68, s7, 1
  s_add_u32 s68, s68, s73
  s_lshl_b32 s68, s68, 8
  s_lshl_b32 s69, s3, 6
  s_add_u32 s68, s68, s69
  s_mul_i32 s68, s68, 896
  s_lshl_b32 s69, s74, 7
  s_add_u32 s68, s68, s69
  s_cmp_lt_u32 s5, 14
  s_cselect_b32 s68, s68, 0x40000000
  s_waitcnt lgkmcnt(0)
  s_add_u32 s28, s8, s66
  s_addc_u32 s29, s9, 0
  s_mov_b32 s30, 0x20000
  s_mov_b32 s31, 0x00020000
  s_mov_b32 s40, s14
  s_mov_b32 s41, s15
  s_mov_b32 s42, 3670016
  s_mov_b32 s43, 0x00020000
  s_add_u32 s32, s10, s66
  s_addc_u32 s33, s11, 0
  s_mov_b32 s34, 0x20000
  s_mov_b32 s35, 0x00020000
  s_mov_b32 s36, s12
  s_mov_b32 s37, s13
  s_mov_b32 s38, 3670016
  s_mov_b32 s39, 0x00020000
  s_mov_b32 m0, s57
  s_mov_b32 s58, s56
  buffer_load_dwordx4 v28, s[36:39], s58 offen nt lds
  s_add_u32 m0, s57, 1024
  s_add_u32 s58, s56, 131072
  buffer_load_dwordx4 v28, s[36:39], s58 offen nt lds
  s_add_u32 m0, s57, 2048
  s_add_u32 s58, s56, 262144
  buffer_load_dwordx4 v28, s[36:39], s58 offen nt lds
  s_add_u32 m0, s57, 3072
  s_add_u32 s58, s56, 393216
  buffer_load_dwordx4 v28, s[36:39], s58 offen nt lds
  s_add_u32 m0, s57, 4096
  s_add_u32 s58, s56, 524288
  buffer_load_dwordx4 v28, s[36:39], s58 offen nt lds
  s_add_u32 m0, s57, 5120
  s_add_u32 s58, s56, 655360
  buffer_load_dwordx4 v28, s[36:39], s58 offen nt lds
  s_add_u32 m0, s57, 6144
  s_add_u32 s58, s56, 786432
  buffer_load_dwordx4 v28, s[36:39], s58 offen nt lds
  s_add_u32 m0, s64, 24576
  s_add_u32 s70, s68, 0
  buffer_load_dwordx4 v29, s[40:43], s70 offen nt lds
  s_add_u32 m0, s64, 25600
  s_add_u32 s70, s68, 7168
  buffer_load_dwordx4 v29, s[40:43], s70 offen nt lds
  s_add_u32 m0, s64, 26624
  s_add_u32 s70, s68, 14336
  buffer_load_dwordx4 v29, s[40:43], s70 offen nt lds
  s_add_u32 m0, s64, 27648
  s_add_u32 s70, s68, 21504
  buffer_load_dwordx4 v29, s[40:43], s70 offen nt lds
  s_add_u32 m0, s64, 28672
  s_add_u32 s70, s68, 28672
  buffer_load_dwordx4 v29, s[40:43], s70 offen nt lds
  s_add_u32 m0, s64, 29696
  s_add_u32 s70, s68, 35840
  buffer_load_dwordx4 v29, s[40:43], s70 offen nt lds
  s_add_u32 m0, s64, 30720
  s_add_u32 s70, s68, 43008
  buffer_load_dwordx4 v29, s[40:43], s70 offen nt lds
  s_add_u32 m0, s64, 31744
  s_add_u32 s70, s68, 50176
  buffer_load_dwordx4 v29, s[40:43], s70 offen nt lds
  s_add_u32 m0, s64, 0
  s_nop 0
  buffer_load_dwordx4 v12, s[28:31], s65 offen offset:0 nt lds
  buffer_load_dwordx4 v13, s[28:31], s65 offen offset:1024 nt lds
  v_and_b32 v4, 7, v2
  v_lshlrev_b32 v4, 1, v4
  v_lshlrev_b32 v5, 9, v2
  v_add_u32 v5, s64, v5
  v_add_u32 v6, 0, v3
  v_xor_b32 v6, v6, v4
  v_lshl_add_u32 v16, v6, 4, v5
  v_add_u32 v6, 4, v3
  v_xor_b32 v6, v6, v4
  v_lshl_add_u32 v17, v6, 4, v5
  v_add_u32 v6, 8, v3
  v_xor_b32 v6, v6, v4
  v_lshl_add_u32 v18, v6, 4, v5
  v_add_u32 v6, 12, v3
  v_xor_b32 v6, v6, v4
  v_lshl_add_u32 v19, v6, 4, v5
  v_lshrrev_b32 v4, 2, v1
  v_and_b32 v5, 3, v1
  v_lshlrev_b32 v5, 3, v5
  v_lshl_add_u32 v5, v4, 9, v5
  v_add_u32 v5, s64, v5
  v_and_b32 v4, 7, v4
  v_xor_b32 v6, 0, v4
  v_lshl_add_u32 v20, v6, 5, v5
  v_xor_b32 v6, 1, v4
  v_lshl_add_u32 v21, v6, 5, v5
  v_xor_b32 v6, 2, v4
  v_lshl_add_u32 v22, v6, 5, v5
  v_xor_b32 v6, 3, v4
  v_lshl_add_u32 v23, v6, 5, v5
  v_xor_b32 v6, 4, v4
  v_lshl_add_u32 v24, v6, 5, v5
  v_xor_b32 v6, 5, v4
  v_lshl_add_u32 v25, v6, 5, v5
  v_xor_b32 v6, 6, v4
  v_lshl_add_u32 v26, v6, 5, v5
  v_xor_b32 v6, 7, v4
  v_lshl_add_u32 v27, v6, 5, v5
  s_mov_b32 s44, s22
  s_mov_b32 s45, s23
  s_mov_b32 s46, 2883584
  s_mov_b32 s47, 0x00020000
  s_mov_b32 s72, 1035512379
  v_mov_b32 v30, 0xff800000
  v_mov_b32 v31, 0
  s_waitcnt vmcnt(10)
  s_barrier
  s_waitcnt vmcnt(8)
  buffer_load_dwordx4 v14, s[28:31], s65 offen offset:2048 nt lds
  buffer_load_dwordx4 v15, s[28:31], s65 offen offset:3072 nt lds
  s_waitcnt vmcnt(8)
  s_add_u32 m0, s64, 4096
  s_add_u32 s61, s65, 4096
  s_and_b32 s61, s61, 0x1ffff
  buffer_load_dwordx4 v12, s[28:31], s61 offen offset:0 nt lds
  buffer_load_dwordx4 v13, s[28:31], s61 offen offset:1024 nt lds
  s_waitcnt vmcnt(8)
  buffer_load_dwordx4 v14, s[28:31], s61 offen offset:2048 nt lds
  buffer_load_dwordx4 v15, s[28:31], s61 offen offset:3072 nt lds
  s_waitcnt vmcnt(8)
  s_add_u32 m0, s64, 8192
  s_add_u32 s61, s65, 8192
  s_and_b32 s61, s61, 0x1ffff
  buffer_load_dwordx4 v12, s[28:31], s61 offen offset:0 nt lds
  buffer_load_dwordx4 v13, s[28:31], s61 offen offset:1024 nt lds
  s_waitcnt vmcnt(8)
  buffer_load_dwordx4 v14, s[28:31], s61 offen offset:2048 nt lds
  buffer_load_dwordx4 v15, s[28:31], s61 offen offset:3072 nt lds
  s_waitcnt vmcnt(8)
  s_add_u32 m0, s64, 12288
  s_add_u32 s61, s65, 12288
  s_and_b32 s61, s61, 0x1ffff
  buffer_load_dwordx4 v12, s[28:31], s61 offen offset:0 nt lds
  buffer_load_dwordx4 v13, s[28:31], s61 offen offset:1024 nt lds
  s_waitcnt vmcnt(8)
  buffer_load_dwordx4 v14, s[28:31], s61 offen offset:2048 nt lds
  buffer_load_dwordx4 v15, s[28:31], s61 offen offset:3072 nt lds
  s_waitcnt vmcnt(8)
  s_add_u32 m0, s64, 16384
  s_add_u32 s61, s65, 16384
  s_and_b32 s61, s61, 0x1ffff
  buffer_load_dwordx4 v12, s[28:31], s61 offen offset:0 nt lds
  buffer_load_dwordx4 v13, s[28:31], s61 offen offset:1024 nt lds
  ds_read_b128 v[192:195], v16 offset:0
  ds_read_b128 v[196:199], v17 offset:0
  ds_read_b128 v[200:203], v18 offset:0
  ds_read_b128 v[204:207], v19 offset:0
  ds_read_b128 v[208:211], v16 offset:256
  ds_read_b128 v[212:215], v17 offset:256
  ds_read_b128 v[216:219], v18 offset:256
  ds_read_b128 v[220:223], v19 offset:256
  s_waitcnt lgkmcnt(0)
  s_waitcnt vmcnt(8)
  buffer_load_dwordx4 v14, s[28:31], s61 offen offset:2048 nt lds
  buffer_load_dwordx4 v15, s[28:31], s61 offen offset:3072 nt lds
  s_waitcnt vmcnt(8)
  s_add_u32 m0, s64, 20480
  s_add_u32 s61, s65, 20480
  s_and_b32 s61, s61, 0x1ffff
  buffer_load_dwordx4 v12, s[28:31], s61 offen offset:0 nt lds
  buffer_load_dwordx4 v13, s[28:31], s61 offen offset:1024 nt lds
  s_waitcnt vmcnt(8)
  buffer_load_dwordx4 v14, s[28:31], s61 offen offset:2048 nt lds
  buffer_load_dwordx4 v15, s[28:31], s61 offen offset:3072 nt lds
  s_waitcnt vmcnt(8)
  s_add_u32 m0, s64, 0
  s_add_u32 s61, s65, 24576
  s_and_b32 s61, s61, 0x1ffff
  buffer_load_dwordx4 v12, s[28:31], s61 offen offset:0 nt lds
  buffer_load_dwordx4 v13, s[28:31], s61 offen offset:1024 nt lds
  ds_read_b128 v[224:227], v16 offset:8192
  ds_read_b128 v[228:231], v17 offset:8192
  ds_read_b128 v[232:235], v18 offset:8192
  ds_read_b128 v[236:239], v19 offset:8192
  ds_read_b128 v[240:243], v16 offset:8448
  ds_read_b128 v[244:247], v17 offset:8448
  ds_read_b128 v[248:251], v18 offset:8448
  ds_read_b128 v[252:255], v19 offset:8448
  s_waitcnt lgkmcnt(0)
  s_waitcnt vmcnt(8)
  buffer_load_dwordx4 v14, s[28:31], s61 offen offset:2048 nt lds
  buffer_load_dwordx4 v15, s[28:31], s61 offen offset:3072 nt lds
  s_waitcnt vmcnt(8)
  s_add_u32 m0, s64, 4096
  s_add_u32 s61, s65, 28672
  s_and_b32 s61, s61, 0x1ffff
  buffer_load_dwordx4 v12, s[28:31], s61 offen offset:0 nt lds
  buffer_load_dwordx4 v13, s[28:31], s61 offen offset:1024 nt lds
  s_waitcnt vmcnt(8)
  buffer_load_dwordx4 v14, s[28:31], s61 offen offset:2048 nt lds
  buffer_load_dwordx4 v15, s[28:31], s61 offen offset:3072 nt lds
  s_waitcnt vmcnt(8)
  s_add_u32 m0, s64, 8192
  s_add_u32 s61, s65, 32768
  s_and_b32 s61, s61, 0x1ffff
  buffer_load_dwordx4 v12, s[28:31], s61 offen offset:0 nt lds
  buffer_load_dwordx4 v13, s[28:31], s61 offen offset:1024 nt lds
  ds_read_b128 v[96:99], v16 offset:16384
  ds_read_b128 v[100:103], v17 offset:16384
  ds_read_b128 v[104:107], v18 offset:16384
  ds_read_b128 v[108:111], v19 offset:16384
  ds_read_b128 v[112:115], v16 offset:16640
  ds_read_b128 v[116:119], v17 offset:16640
  ds_read_b128 v[120:123], v18 offset:16640
  ds_read_b128 v[124:127], v19 offset:16640
  s_waitcnt lgkmcnt(0)
  s_waitcnt vmcnt(8)
  buffer_load_dwordx4 v14, s[28:31], s61 offen offset:2048 nt lds
  buffer_load_dwordx4 v15, s[28:31], s61 offen offset:3072 nt lds
  s_waitcnt vmcnt(8)
  s_add_u32 m0, s64, 12288
  s_add_u32 s61, s65, 36864
  s_and_b32 s61, s61, 0x1ffff
  buffer_load_dwordx4 v12, s[28:31], s61 offen offset:0 nt lds
  buffer_load_dwordx4 v13, s[28:31], s61 offen offset:1024 nt lds
  s_waitcnt vmcnt(8)
  buffer_load_dwordx4 v14, s[28:31], s61 offen offset:2048 nt lds
  buffer_load_dwordx4 v15, s[28:31], s61 offen offset:3072 nt lds
  s_waitcnt vmcnt(8)
  s_add_u32 m0, s64, 16384
  s_add_u32 s61, s65, 40960
  s_and_b32 s61, s61, 0x1ffff
  buffer_load_dwordx4 v12, s[28:31], s61 offen offset:0 nt lds
  buffer_load_dwordx4 v13, s[28:31], s61 offen offset:1024 nt lds
  ds_read_b128 v[160:163], v16 offset:0
  ds_read_b128 v[164:167], v17 offset:0
  ds_read_b128 v[168:171], v18 offset:0
  ds_read_b128 v[172:175], v19 offset:0
  ds_read_b128 v[176:179], v16 offset:256
  ds_read_b128 v[180:183], v17 offset:256
  ds_read_b128 v[184:187], v18 offset:256
  ds_read_b128 v[188:191], v19 offset:256
  s_waitcnt lgkmcnt(0)
  s_waitcnt vmcnt(8)
  buffer_load_dwordx4 v14, s[28:31], s61 offen offset:2048 nt lds
  buffer_load_dwordx4 v15, s[28:31], s61 offen offset:3072 nt lds
  s_waitcnt vmcnt(8)
  s_add_u32 m0, s64, 20480
  s_add_u32 s61, s65, 45056
  s_and_b32 s61, s61, 0x1ffff
  buffer_load_dwordx4 v12, s[28:31], s61 offen offset:0 nt lds
  buffer_load_dwordx4 v13, s[28:31], s61 offen offset:1024 nt lds
  s_waitcnt vmcnt(8)
  buffer_load_dwordx4 v14, s[28:31], s61 offen offset:2048 nt lds
  buffer_load_dwordx4 v15, s[28:31], s61 offen offset:3072 nt lds
  s_waitcnt vmcnt(8)
  s_add_u32 m0, s64, 0
  s_add_u32 s61, s65, 49152
  s_and_b32 s61, s61, 0x1ffff
  buffer_load_dwordx4 v12, s[28:31], s61 offen offset:0 nt lds
  buffer_load_dwordx4 v13, s[28:31], s61 offen offset:1024 nt lds
  ds_read_b128 v[32:35], v16 offset:8192
  ds_read_b128 v[36:39], v17 offset:8192
  ds_read_b128 v[40:43], v18 offset:8192
  ds_read_b128 v[44:47], v19 offset:8192
  ds_read_b128 v[48:51], v16 offset:8448
  ds_read_b128 v[52:55], v17 offset:8448
  ds_read_b128 v[56:59], v18 offset:8448
  ds_read_b128 v[60:63], v19 offset:8448
  s_waitcnt lgkmcnt(0)
  s_waitcnt vmcnt(8)
  buffer_load_dwordx4 v14, s[28:31], s61 offen offset:2048 nt lds
  buffer_load_dwordx4 v15, s[28:31], s61 offen offset:3072 nt lds
  s_waitcnt vmcnt(8)
  s_add_u32 m0, s64, 4096
  s_add_u32 s61, s65, 53248
  s_and_b32 s61, s61, 0x1ffff
  buffer_load_dwordx4 v12, s[28:31], s61 offen offset:0 nt lds
  buffer_load_dwordx4 v13, s[28:31], s61 offen offset:1024 nt lds
  s_waitcnt vmcnt(8)
  buffer_load_dwordx4 v14, s[28:31], s61 offen offset:2048 nt lds
  buffer_load_dwordx4 v15, s[28:31], s61 offen offset:3072 nt lds
  s_waitcnt vmcnt(8)
  s_add_u32 m0, s64, 8192
  s_add_u32 s61, s65, 57344
  s_and_b32 s61, s61, 0x1ffff
  buffer_load_dwordx4 v12, s[28:31], s61 offen offset:0 nt lds
  buffer_load_dwordx4 v13, s[28:31], s61 offen offset:1024 nt lds
  s_waitcnt vmcnt(8)
  buffer_load_dwordx4 v14, s[28:31], s61 offen offset:2048 nt lds
  buffer_load_dwordx4 v15, s[28:31], s61 offen offset:3072 nt lds
  s_waitcnt vmcnt(8)
  s_add_u32 m0, s64, 12288
  s_add_u32 s61, s65, 61440
  s_and_b32 s61, s61, 0x1ffff
  buffer_load_dwordx4 v12, s[28:31], s61 offen offset:0 nt lds
  buffer_load_dwordx4 v13, s[28:31], s61 offen offset:1024 nt lds
  s_waitcnt vmcnt(8)
  buffer_load_dwordx4 v14, s[28:31], s61 offen offset:2048 nt lds
  buffer_load_dwordx4 v15, s[28:31], s61 offen offset:3072 nt lds
  s_waitcnt vmcnt(8)
  s_waitcnt vmcnt(6)
  s_waitcnt vmcnt(4)
  s_waitcnt vmcnt(2)
  s_waitcnt vmcnt(0)
  s_barrier
  v_and_b32 v4, 1, v2
  v_lshlrev_b32 v4, 9, v4
  v_lshl_add_u32 v4, v3, 4, v4
  v_add_u32 v4, 159744, v4
  ds_read_b128 v[128:131], v4 offset:0
  ds_read_b128 v[132:135], v4 offset:64
  ds_read_b128 v[136:139], v4 offset:128
  ds_read_b128 v[140:143], v4 offset:192
  ds_read_b128 v[144:147], v4 offset:256
  ds_read_b128 v[148:151], v4 offset:320
  ds_read_b128 v[152:155], v4 offset:384
  ds_read_b128 v[156:159], v4 offset:448
  s_waitcnt lgkmcnt(0)
  v_mfma_f32_16x16x32_bf16 v[64:67], v[32:35], v[128:131], 0
  v_mfma_f32_16x16x32_bf16 v[64:67], v[36:39], v[132:135], v[64:67]
  v_mfma_f32_16x16x32_bf16 v[64:67], v[40:43], v[136:139], v[64:67]
  v_mfma_f32_16x16x32_bf16 v[64:67], v[44:47], v[140:143], v[64:67]
  v_mfma_f32_16x16x32_bf16 v[64:67], v[48:51], v[144:147], v[64:67]
  v_mfma_f32_16x16x32_bf16 v[64:67], v[52:55], v[148:151], v[64:67]
  v_mfma_f32_16x16x32_bf16 v[64:67], v[56:59], v[152:155], v[64:67]
  v_mfma_f32_16x16x32_bf16 v[64:67], v[60:63], v[156:159], v[64:67]
  v_mfma_f32_16x16x32_bf16 v[68:71], v[160:163], v[128:131], 0
  v_mfma_f32_16x16x32_bf16 v[68:71], v[164:167], v[132:135], v[68:71]
  v_mfma_f32_16x16x32_bf16 v[68:71], v[168:171], v[136:139], v[68:71]
  v_mfma_f32_16x16x32_bf16 v[68:71], v[172:175], v[140:143], v[68:71]
  v_mfma_f32_16x16x32_bf16 v[68:71], v[176:179], v[144:147], v[68:71]
  v_mfma_f32_16x16x32_bf16 v[68:71], v[180:183], v[148:151], v[68:71]
  v_mfma_f32_16x16x32_bf16 v[68:71], v[184:187], v[152:155], v[68:71]
  v_mfma_f32_16x16x32_bf16 v[68:71], v[188:191], v[156:159], v[68:71]
  v_max3_f32 v30, v30, v64, v65
  v_max3_f32 v30, v30, v66, v67
  ds_read_b128 v[32:35], v16 offset:16384
  ds_read_b128 v[36:39], v17 offset:16384
  ds_read_b128 v[40:43], v18 offset:16384
  ds_read_b128 v[44:47], v19 offset:16384
  ds_read_b128 v[48:51], v16 offset:16640
  ds_read_b128 v[52:55], v17 offset:16640
  ds_read_b128 v[56:59], v18 offset:16640
  ds_read_b128 v[60:63], v19 offset:16640
  v_max3_f32 v30, v30, v68, v69
  v_max3_f32 v30, v30, v70, v71
  s_waitcnt lgkmcnt(7)
  v_mfma_f32_16x16x32_bf16 v[72:75], v[32:35], v[128:131], 0
  s_waitcnt lgkmcnt(6)
  v_mfma_f32_16x16x32_bf16 v[72:75], v[36:39], v[132:135], v[72:75]
  s_waitcnt lgkmcnt(5)
  v_mfma_f32_16x16x32_bf16 v[72:75], v[40:43], v[136:139], v[72:75]
  s_waitcnt lgkmcnt(4)
  v_mfma_f32_16x16x32_bf16 v[72:75], v[44:47], v[140:143], v[72:75]
  s_waitcnt lgkmcnt(3)
  v_mfma_f32_16x16x32_bf16 v[72:75], v[48:51], v[144:147], v[72:75]
  s_waitcnt lgkmcnt(2)
  v_mfma_f32_16x16x32_bf16 v[72:75], v[52:55], v[148:151], v[72:75]
  s_waitcnt lgkmcnt(1)
  v_mfma_f32_16x16x32_bf16 v[72:75], v[56:59], v[152:155], v[72:75]
  s_waitcnt lgkmcnt(0)
  v_mfma_f32_16x16x32_bf16 v[72:75], v[60:63], v[156:159], v[72:75]
  s_add_u32 m0, s64, 16384
  s_add_u32 s61, s65, 65536
  s_and_b32 s61, s61, 0x1ffff
  buffer_load_dwordx4 v12, s[28:31], s61 offen offset:0 nt lds
  buffer_load_dwordx4 v13, s[28:31], s61 offen offset:1024 nt lds
  buffer_load_dwordx4 v14, s[28:31], s61 offen offset:2048 nt lds
  buffer_load_dwordx4 v15, s[28:31], s61 offen offset:3072 nt lds
  s_add_u32 m0, s64, 20480
  s_add_u32 s61, s65, 69632
  s_and_b32 s61, s61, 0x1ffff
  buffer_load_dwordx4 v12, s[28:31], s61 offen offset:0 nt lds
  buffer_load_dwordx4 v13, s[28:31], s61 offen offset:1024 nt lds
  buffer_load_dwordx4 v14, s[28:31], s61 offen offset:2048 nt lds
  buffer_load_dwordx4 v15, s[28:31], s61 offen offset:3072 nt lds
  ds_read_b128 v[32:35], v16 offset:0
  ds_read_b128 v[36:39], v17 offset:0
  ds_read_b128 v[40:43], v18 offset:0
  ds_read_b128 v[44:47], v19 offset:0
  ds_read_b128 v[48:51], v16 offset:256
  ds_read_b128 v[52:55], v17 offset:256
  ds_read_b128 v[56:59], v18 offset:256
  ds_read_b128 v[60:63], v19 offset:256
  v_max3_f32 v30, v30, v72, v73
  v_max3_f32 v30, v30, v74, v75
  s_waitcnt lgkmcnt(7)
  v_mfma_f32_16x16x32_bf16 v[76:79], v[32:35], v[128:131], 0
  s_waitcnt lgkmcnt(6)
  v_mfma_f32_16x16x32_bf16 v[76:79], v[36:39], v[132:135], v[76:79]
  s_waitcnt lgkmcnt(5)
  v_mfma_f32_16x16x32_bf16 v[76:79], v[40:43], v[136:139], v[76:79]
  s_waitcnt lgkmcnt(4)
  v_mfma_f32_16x16x32_bf16 v[76:79], v[44:47], v[140:143], v[76:79]
  s_waitcnt lgkmcnt(3)
  v_mfma_f32_16x16x32_bf16 v[76:79], v[48:51], v[144:147], v[76:79]
  s_waitcnt lgkmcnt(2)
  v_mfma_f32_16x16x32_bf16 v[76:79], v[52:55], v[148:151], v[76:79]
  s_waitcnt lgkmcnt(1)
  v_mfma_f32_16x16x32_bf16 v[76:79], v[56:59], v[152:155], v[76:79]
  s_waitcnt lgkmcnt(0)
  v_mfma_f32_16x16x32_bf16 v[76:79], v[60:63], v[156:159], v[76:79]
  s_add_u32 m0, s64, 0
  s_add_u32 s61, s65, 73728
  s_and_b32 s61, s61, 0x1ffff
  buffer_load_dwordx4 v12, s[28:31], s61 offen offset:0 nt lds
  buffer_load_dwordx4 v13, s[28:31], s61 offen offset:1024 nt lds
  ds_read_b128 v[32:35], v16 offset:8192
  ds_read_b128 v[36:39], v17 offset:8192
  ds_read_b128 v[40:43], v18 offset:8192
  ds_read_b128 v[44:47], v19 offset:8192
  ds_read_b128 v[48:51], v16 offset:8448
  ds_read_b128 v[52:55], v17 offset:8448
  ds_read_b128 v[56:59], v18 offset:8448
  ds_read_b128 v[60:63], v19 offset:8448
  v_max3_f32 v30, v30, v76, v77
  v_max3_f32 v30, v30, v78, v79
  s_waitcnt lgkmcnt(7)
  v_mfma_f32_16x16x32_bf16 v[80:83], v[32:35], v[128:131], 0
  s_waitcnt lgkmcnt(6)
  v_mfma_f32_16x16x32_bf16 v[80:83], v[36:39], v[132:135], v[80:83]
  s_waitcnt lgkmcnt(5)
  v_mfma_f32_16x16x32_bf16 v[80:83], v[40:43], v[136:139], v[80:83]
  s_waitcnt lgkmcnt(4)
  v_mfma_f32_16x16x32_bf16 v[80:83], v[44:47], v[140:143], v[80:83]
  s_waitcnt lgkmcnt(3)
  v_mfma_f32_16x16x32_bf16 v[80:83], v[48:51], v[144:147], v[80:83]
  s_waitcnt lgkmcnt(2)
  v_mfma_f32_16x16x32_bf16 v[80:83], v[52:55], v[148:151], v[80:83]
  s_waitcnt lgkmcnt(1)
  v_mfma_f32_16x16x32_bf16 v[80:83], v[56:59], v[152:155], v[80:83]
  s_waitcnt lgkmcnt(0)
  v_mfma_f32_16x16x32_bf16 v[80:83], v[60:63], v[156:159], v[80:83]
  v_bfe_u32 v5, v1, 2, 2
  v_lshl_add_u32 v5, v3, 3, v5
  v_and_b32 v6, 3, v1
  v_lshlrev_b32 v6, 3, v6
  v_lshl_add_u32 v6, v5, 7, v6
  v_bfe_u32 v7, v5, 1, 2
  v_xor_b32 v8, s3, v7
  v_lshl_add_u32 v8, v8, 5, v6
  v_add_u32 v7, 2, v7
  v_and_b32 v7, 3, v7
  v_xor_b32 v9, s3, v7
  v_lshl_add_u32 v9, v9, 5, v6
  v_add_u32 v9, 512, v9
  v_add_u32 v10, 0x10000, v8
  v_add_u32 v11, 0x10000, v9
  ds_read_b64_tr_b16 v[160:161], v8 offset:24576
  ds_read_b64_tr_b16 v[162:163], v9 offset:24576
  ds_read_b64_tr_b16 v[164:165], v8 offset:28672
  ds_read_b64_tr_b16 v[166:167], v9 offset:28672
  ds_read_b64_tr_b16 v[168:169], v8 offset:57344
  ds_read_b64_tr_b16 v[170:171], v9 offset:57344
  ds_read_b64_tr_b16 v[172:173], v8 offset:61440
  ds_read_b64_tr_b16 v[174:175], v9 offset:61440
  ds_read_b64_tr_b16 v[176:177], v10 offset:24576
  ds_read_b64_tr_b16 v[178:179], v11 offset:24576
  ds_read_b64_tr_b16 v[180:181], v10 offset:28672
  ds_read_b64_tr_b16 v[182:183], v11 offset:28672
  ds_read_b64_tr_b16 v[184:185], v10 offset:57344
  ds_read_b64_tr_b16 v[186:187], v11 offset:57344
  ds_read_b64_tr_b16 v[188:189], v10 offset:61440
  ds_read_b64_tr_b16 v[190:191], v11 offset:61440
  s_waitcnt lgkmcnt(0)
  s_barrier
  v_mfma_f32_16x16x32_bf16 v[84:87], v[192:195], v[128:131], 0
  v_mfma_f32_16x16x32_bf16 v[84:87], v[196:199], v[132:135], v[84:87]
  v_mfma_f32_16x16x32_bf16 v[84:87], v[200:203], v[136:139], v[84:87]
  v_mfma_f32_16x16x32_bf16 v[84:87], v[204:207], v[140:143], v[84:87]
  v_mfma_f32_16x16x32_bf16 v[84:87], v[208:211], v[144:147], v[84:87]
  v_mfma_f32_16x16x32_bf16 v[84:87], v[212:215], v[148:151], v[84:87]
  v_mfma_f32_16x16x32_bf16 v[84:87], v[216:219], v[152:155], v[84:87]
  v_mfma_f32_16x16x32_bf16 v[84:87], v[220:223], v[156:159], v[84:87]
  v_max3_f32 v30, v30, v80, v81
  v_max3_f32 v30, v30, v82, v83
  v_mfma_f32_16x16x32_bf16 v[88:91], v[224:227], v[128:131], 0
  v_mfma_f32_16x16x32_bf16 v[88:91], v[228:231], v[132:135], v[88:91]
  v_mfma_f32_16x16x32_bf16 v[88:91], v[232:235], v[136:139], v[88:91]
  v_mfma_f32_16x16x32_bf16 v[88:91], v[236:239], v[140:143], v[88:91]
  v_mfma_f32_16x16x32_bf16 v[88:91], v[240:243], v[144:147], v[88:91]
  v_mfma_f32_16x16x32_bf16 v[88:91], v[244:247], v[148:151], v[88:91]
  v_mfma_f32_16x16x32_bf16 v[88:91], v[248:251], v[152:155], v[88:91]
  v_mfma_f32_16x16x32_bf16 v[88:91], v[252:255], v[156:159], v[88:91]
  v_max3_f32 v30, v30, v84, v85
  v_max3_f32 v30, v30, v86, v87
  v_mfma_f32_16x16x32_bf16 v[92:95], v[96:99], v[128:131], 0
  v_mfma_f32_16x16x32_bf16 v[92:95], v[100:103], v[132:135], v[92:95]
  v_mfma_f32_16x16x32_bf16 v[92:95], v[104:107], v[136:139], v[92:95]
  v_mfma_f32_16x16x32_bf16 v[92:95], v[108:111], v[140:143], v[92:95]
  v_mfma_f32_16x16x32_bf16 v[92:95], v[112:115], v[144:147], v[92:95]
  v_mfma_f32_16x16x32_bf16 v[92:95], v[116:119], v[148:151], v[92:95]
  v_mfma_f32_16x16x32_bf16 v[92:95], v[120:123], v[152:155], v[92:95]
  v_mfma_f32_16x16x32_bf16 v[92:95], v[124:127], v[156:159], v[92:95]
  v_max3_f32 v30, v30, v88, v89
  v_max3_f32 v30, v30, v90, v91
  s_waitcnt vmcnt(8)
  buffer_load_dwordx4 v14, s[28:31], s61 offen offset:2048 nt lds
  buffer_load_dwordx4 v15, s[28:31], s61 offen offset:3072 nt lds
  s_waitcnt vmcnt(8)
  s_add_u32 m0, s64, 4096
  s_add_u32 s61, s65, 77824
  s_and_b32 s61, s61, 0x1ffff
  buffer_load_dwordx4 v12, s[28:31], s61 offen offset:0 nt lds
  buffer_load_dwordx4 v13, s[28:31], s61 offen offset:1024 nt lds
  s_waitcnt vmcnt(8)
  buffer_load_dwordx4 v14, s[28:31], s61 offen offset:2048 nt lds
  buffer_load_dwordx4 v15, s[28:31], s61 offen offset:3072 nt lds
  s_waitcnt vmcnt(8)
  s_add_u32 m0, s64, 8192
  s_add_u32 s61, s65, 81920
  s_and_b32 s61, s61, 0x1ffff
  buffer_load_dwordx4 v12, s[28:31], s61 offen offset:0 nt lds
  buffer_load_dwordx4 v13, s[28:31], s61 offen offset:1024 nt lds
  ds_read_b128 v[32:35], v16 offset:16384
  ds_read_b128 v[36:39], v17 offset:16384
  ds_read_b128 v[40:43], v18 offset:16384
  ds_read_b128 v[44:47], v19 offset:16384
  ds_read_b128 v[48:51], v16 offset:16640
  ds_read_b128 v[52:55], v17 offset:16640
  ds_read_b128 v[56:59], v18 offset:16640
  ds_read_b128 v[60:63], v19 offset:16640
  v_max3_f32 v30, v30, v92, v93
  v_max3_f32 v30, v30, v94, v95
  s_waitcnt lgkmcnt(7)
  v_mfma_f32_16x16x32_bf16 v[96:99], v[32:35], v[128:131], 0
  s_waitcnt lgkmcnt(6)
  v_mfma_f32_16x16x32_bf16 v[96:99], v[36:39], v[132:135], v[96:99]
  s_waitcnt lgkmcnt(5)
  v_mfma_f32_16x16x32_bf16 v[96:99], v[40:43], v[136:139], v[96:99]
  s_waitcnt lgkmcnt(4)
  v_mfma_f32_16x16x32_bf16 v[96:99], v[44:47], v[140:143], v[96:99]
  s_waitcnt lgkmcnt(3)
  v_mfma_f32_16x16x32_bf16 v[96:99], v[48:51], v[144:147], v[96:99]
  s_waitcnt lgkmcnt(2)
  v_mfma_f32_16x16x32_bf16 v[96:99], v[52:55], v[148:151], v[96:99]
  s_waitcnt lgkmcnt(1)
  v_mfma_f32_16x16x32_bf16 v[96:99], v[56:59], v[152:155], v[96:99]
  s_waitcnt lgkmcnt(0)
  v_mfma_f32_16x16x32_bf16 v[96:99], v[60:63], v[156:159], v[96:99]
  s_waitcnt vmcnt(8)
  buffer_load_dwordx4 v14, s[28:31], s61 offen offset:2048 nt lds
  buffer_load_dwordx4 v15, s[28:31], s61 offen offset:3072 nt lds
  s_waitcnt vmcnt(8)
  s_add_u32 m0, s64, 12288
  s_add_u32 s61, s65, 86016
  s_and_b32 s61, s61, 0x1ffff
  buffer_load_dwordx4 v12, s[28:31], s61 offen offset:0 nt lds
  buffer_load_dwordx4 v13, s[28:31], s61 offen offset:1024 nt lds
  s_waitcnt vmcnt(8)
  buffer_load_dwordx4 v14, s[28:31], s61 offen offset:2048 nt lds
  buffer_load_dwordx4 v15, s[28:31], s61 offen offset:3072 nt lds
  s_waitcnt vmcnt(8)
  s_add_u32 m0, s64, 24576
  s_add_u32 s61, s65, 90112
  s_and_b32 s61, s61, 0x1ffff
  buffer_load_dwordx4 v12, s[28:31], s61 offen offset:0 nt lds
  buffer_load_dwordx4 v13, s[28:31], s61 offen offset:1024 nt lds
  ds_read_b128 v[32:35], v16 offset:0
  ds_read_b128 v[36:39], v17 offset:0
  ds_read_b128 v[40:43], v18 offset:0
  ds_read_b128 v[44:47], v19 offset:0
  ds_read_b128 v[48:51], v16 offset:256
  ds_read_b128 v[52:55], v17 offset:256
  ds_read_b128 v[56:59], v18 offset:256
  ds_read_b128 v[60:63], v19 offset:256
  v_max3_f32 v30, v30, v96, v97
  v_max3_f32 v30, v30, v98, v99
  s_waitcnt lgkmcnt(7)
  v_mfma_f32_16x16x32_bf16 v[100:103], v[32:35], v[128:131], 0
  s_waitcnt lgkmcnt(6)
  v_mfma_f32_16x16x32_bf16 v[100:103], v[36:39], v[132:135], v[100:103]
  s_waitcnt lgkmcnt(5)
  v_mfma_f32_16x16x32_bf16 v[100:103], v[40:43], v[136:139], v[100:103]
  s_waitcnt lgkmcnt(4)
  v_mfma_f32_16x16x32_bf16 v[100:103], v[44:47], v[140:143], v[100:103]
  s_waitcnt lgkmcnt(3)
  v_mfma_f32_16x16x32_bf16 v[100:103], v[48:51], v[144:147], v[100:103]
  s_waitcnt lgkmcnt(2)
  v_mfma_f32_16x16x32_bf16 v[100:103], v[52:55], v[148:151], v[100:103]
  s_waitcnt lgkmcnt(1)
  v_mfma_f32_16x16x32_bf16 v[100:103], v[56:59], v[152:155], v[100:103]
  s_waitcnt lgkmcnt(0)
  v_mfma_f32_16x16x32_bf16 v[100:103], v[60:63], v[156:159], v[100:103]
  s_waitcnt vmcnt(8)
  buffer_load_dwordx4 v14, s[28:31], s61 offen offset:2048 nt lds
  buffer_load_dwordx4 v15, s[28:31], s61 offen offset:3072 nt lds
  s_waitcnt vmcnt(8)
  s_add_u32 m0, s64, 28672
  s_add_u32 s61, s65, 94208
  s_and_b32 s61, s61, 0x1ffff
  buffer_load_dwordx4 v12, s[28:31], s61 offen offset:0 nt lds
  buffer_load_dwordx4 v13, s[28:31], s61 offen offset:1024 nt lds
  s_waitcnt vmcnt(8)
  buffer_load_dwordx4 v14, s[28:31], s61 offen offset:2048 nt lds
  buffer_load_dwordx4 v15, s[28:31], s61 offen offset:3072 nt lds
  s_waitcnt vmcnt(8)
  s_add_u32 m0, s64, 16384
  s_add_u32 s61, s65, 98304
  s_and_b32 s61, s61, 0x1ffff
  buffer_load_dwordx4 v12, s[28:31], s61 offen offset:0 nt lds
  buffer_load_dwordx4 v13, s[28:31], s61 offen offset:1024 nt lds
  ds_read_b128 v[32:35], v16 offset:8192
  ds_read_b128 v[36:39], v17 offset:8192
  ds_read_b128 v[40:43], v18 offset:8192
  ds_read_b128 v[44:47], v19 offset:8192
  ds_read_b128 v[48:51], v16 offset:8448
  ds_read_b128 v[52:55], v17 offset:8448
  ds_read_b128 v[56:59], v18 offset:8448
  ds_read_b128 v[60:63], v19 offset:8448
  v_max3_f32 v30, v30, v100, v101
  v_max3_f32 v30, v30, v102, v103
  s_waitcnt lgkmcnt(7)
  v_mfma_f32_16x16x32_bf16 v[104:107], v[32:35], v[128:131], 0
  s_waitcnt lgkmcnt(6)
  v_mfma_f32_16x16x32_bf16 v[104:107], v[36:39], v[132:135], v[104:107]
  s_waitcnt lgkmcnt(5)
  v_mfma_f32_16x16x32_bf16 v[104:107], v[40:43], v[136:139], v[104:107]
  s_waitcnt lgkmcnt(4)
  v_mfma_f32_16x16x32_bf16 v[104:107], v[44:47], v[140:143], v[104:107]
  s_waitcnt lgkmcnt(3)
  v_mfma_f32_16x16x32_bf16 v[104:107], v[48:51], v[144:147], v[104:107]
  s_waitcnt lgkmcnt(2)
  v_mfma_f32_16x16x32_bf16 v[104:107], v[52:55], v[148:151], v[104:107]
  s_waitcnt lgkmcnt(1)
  v_mfma_f32_16x16x32_bf16 v[104:107], v[56:59], v[152:155], v[104:107]
  s_waitcnt lgkmcnt(0)
  v_mfma_f32_16x16x32_bf16 v[104:107], v[60:63], v[156:159], v[104:107]
  s_waitcnt vmcnt(8)
  buffer_load_dwordx4 v14, s[28:31], s61 offen offset:2048 nt lds
  buffer_load_dwordx4 v15, s[28:31], s61 offen offset:3072 nt lds
  s_waitcnt vmcnt(8)
  s_add_u32 m0, s64, 20480
  s_add_u32 s61, s65, 102400
  s_and_b32 s61, s61, 0x1ffff
  buffer_load_dwordx4 v12, s[28:31], s61 offen offset:0 nt lds
  buffer_load_dwordx4 v13, s[28:31], s61 offen offset:1024 nt lds
  s_waitcnt vmcnt(8)
  buffer_load_dwordx4 v14, s[28:31], s61 offen offset:2048 nt lds
  buffer_load_dwordx4 v15, s[28:31], s61 offen offset:3072 nt lds
  s_waitcnt vmcnt(8)
  s_add_u32 m0, s64, 0
  s_add_u32 s61, s65, 106496
  s_and_b32 s61, s61, 0x1ffff
  buffer_load_dwordx4 v12, s[28:31], s61 offen offset:0 nt lds
  buffer_load_dwordx4 v13, s[28:31], s61 offen offset:1024 nt lds
  ds_read_b128 v[32:35], v16 offset:24576
  ds_read_b128 v[36:39], v17 offset:24576
  ds_read_b128 v[40:43], v18 offset:24576
  ds_read_b128 v[44:47], v19 offset:24576
  ds_read_b128 v[48:51], v16 offset:24832
  ds_read_b128 v[52:55], v17 offset:24832
  ds_read_b128 v[56:59], v18 offset:24832
  ds_read_b128 v[60:63], v19 offset:24832
  v_max3_f32 v30, v30, v104, v105
  v_max3_f32 v30, v30, v106, v107
  s_waitcnt lgkmcnt(7)
  v_mfma_f32_16x16x32_bf16 v[108:111], v[32:35], v[128:131], 0
  s_waitcnt lgkmcnt(6)
  v_mfma_f32_16x16x32_bf16 v[108:111], v[36:39], v[132:135], v[108:111]
  s_waitcnt lgkmcnt(5)
  v_mfma_f32_16x16x32_bf16 v[108:111], v[40:43], v[136:139], v[108:111]
  s_waitcnt lgkmcnt(4)
  v_mfma_f32_16x16x32_bf16 v[108:111], v[44:47], v[140:143], v[108:111]
  s_waitcnt lgkmcnt(3)
  v_mfma_f32_16x16x32_bf16 v[108:111], v[48:51], v[144:147], v[108:111]
  s_waitcnt lgkmcnt(2)
  v_mfma_f32_16x16x32_bf16 v[108:111], v[52:55], v[148:151], v[108:111]
  s_waitcnt lgkmcnt(1)
  v_mfma_f32_16x16x32_bf16 v[108:111], v[56:59], v[152:155], v[108:111]
  s_waitcnt lgkmcnt(0)
  v_mfma_f32_16x16x32_bf16 v[108:111], v[60:63], v[156:159], v[108:111]
  s_waitcnt vmcnt(8)
  buffer_load_dwordx4 v14, s[28:31], s61 offen offset:2048 nt lds
  buffer_load_dwordx4 v15, s[28:31], s61 offen offset:3072 nt lds
  s_waitcnt vmcnt(8)
  s_add_u32 m0, s64, 4096
  s_add_u32 s61, s65, 110592
  s_and_b32 s61, s61, 0x1ffff
  buffer_load_dwordx4 v12, s[28:31], s61 offen offset:0 nt lds
  buffer_load_dwordx4 v13, s[28:31], s61 offen offset:1024 nt lds
  s_waitcnt vmcnt(8)
  buffer_load_dwordx4 v14, s[28:31], s61 offen offset:2048 nt lds
  buffer_load_dwordx4 v15, s[28:31], s61 offen offset:3072 nt lds
  s_waitcnt vmcnt(8)
  s_add_u32 m0, s64, 8192
  s_add_u32 s61, s65, 114688
  s_and_b32 s61, s61, 0x1ffff
  buffer_load_dwordx4 v12, s[28:31], s61 offen offset:0 nt lds
  buffer_load_dwordx4 v13, s[28:31], s61 offen offset:1024 nt lds
  ds_read_b128 v[32:35], v16 offset:16384
  ds_read_b128 v[36:39], v17 offset:16384
  ds_read_b128 v[40:43], v18 offset:16384
  ds_read_b128 v[44:47], v19 offset:16384
  ds_read_b128 v[48:51], v16 offset:16640
  ds_read_b128 v[52:55], v17 offset:16640
  ds_read_b128 v[56:59], v18 offset:16640
  ds_read_b128 v[60:63], v19 offset:16640
  v_max3_f32 v30, v30, v108, v109
  v_max3_f32 v30, v30, v110, v111
  s_waitcnt lgkmcnt(7)
  v_mfma_f32_16x16x32_bf16 v[112:115], v[32:35], v[128:131], 0
  s_waitcnt lgkmcnt(6)
  v_mfma_f32_16x16x32_bf16 v[112:115], v[36:39], v[132:135], v[112:115]
  s_waitcnt lgkmcnt(5)
  v_mfma_f32_16x16x32_bf16 v[112:115], v[40:43], v[136:139], v[112:115]
  s_waitcnt lgkmcnt(4)
  v_mfma_f32_16x16x32_bf16 v[112:115], v[44:47], v[140:143], v[112:115]
  s_waitcnt lgkmcnt(3)
  v_mfma_f32_16x16x32_bf16 v[112:115], v[48:51], v[144:147], v[112:115]
  s_waitcnt lgkmcnt(2)
  v_mfma_f32_16x16x32_bf16 v[112:115], v[52:55], v[148:151], v[112:115]
  s_waitcnt lgkmcnt(1)
  v_mfma_f32_16x16x32_bf16 v[112:115], v[56:59], v[152:155], v[112:115]
  s_waitcnt lgkmcnt(0)
  v_mfma_f32_16x16x32_bf16 v[112:115], v[60:63], v[156:159], v[112:115]
  s_waitcnt vmcnt(8)
  buffer_load_dwordx4 v14, s[28:31], s61 offen offset:2048 nt lds
  buffer_load_dwordx4 v15, s[28:31], s61 offen offset:3072 nt lds
  s_waitcnt vmcnt(8)
  s_add_u32 m0, s64, 12288
  s_add_u32 s61, s65, 118784
  s_and_b32 s61, s61, 0x1ffff
  buffer_load_dwordx4 v12, s[28:31], s61 offen offset:0 nt lds
  buffer_load_dwordx4 v13, s[28:31], s61 offen offset:1024 nt lds
  s_waitcnt vmcnt(8)
  buffer_load_dwordx4 v14, s[28:31], s61 offen offset:2048 nt lds
  buffer_load_dwordx4 v15, s[28:31], s61 offen offset:3072 nt lds
  s_waitcnt vmcnt(8)
  s_add_u32 m0, s64, 24576
  s_add_u32 s61, s65, 122880
  s_and_b32 s61, s61, 0x1ffff
  buffer_load_dwordx4 v12, s[28:31], s61 offen offset:0 nt lds
  buffer_load_dwordx4 v13, s[28:31], s61 offen offset:1024 nt lds
  ds_read_b128 v[32:35], v16 offset:0
  ds_read_b128 v[36:39], v17 offset:0
  ds_read_b128 v[40:43], v18 offset:0
  ds_read_b128 v[44:47], v19 offset:0
  ds_read_b128 v[48:51], v16 offset:256
  ds_read_b128 v[52:55], v17 offset:256
  ds_read_b128 v[56:59], v18 offset:256
  ds_read_b128 v[60:63], v19 offset:256
  v_max3_f32 v30, v30, v112, v113
  v_max3_f32 v30, v30, v114, v115
  s_waitcnt lgkmcnt(7)
  v_mfma_f32_16x16x32_bf16 v[116:119], v[32:35], v[128:131], 0
  s_waitcnt lgkmcnt(6)
  v_mfma_f32_16x16x32_bf16 v[116:119], v[36:39], v[132:135], v[116:119]
  s_waitcnt lgkmcnt(5)
  v_mfma_f32_16x16x32_bf16 v[116:119], v[40:43], v[136:139], v[116:119]
  s_waitcnt lgkmcnt(4)
  v_mfma_f32_16x16x32_bf16 v[116:119], v[44:47], v[140:143], v[116:119]
  s_waitcnt lgkmcnt(3)
  v_mfma_f32_16x16x32_bf16 v[116:119], v[48:51], v[144:147], v[116:119]
  s_waitcnt lgkmcnt(2)
  v_mfma_f32_16x16x32_bf16 v[116:119], v[52:55], v[148:151], v[116:119]
  s_waitcnt lgkmcnt(1)
  v_mfma_f32_16x16x32_bf16 v[116:119], v[56:59], v[152:155], v[116:119]
  s_waitcnt lgkmcnt(0)
  v_mfma_f32_16x16x32_bf16 v[116:119], v[60:63], v[156:159], v[116:119]
  s_waitcnt vmcnt(8)
  buffer_load_dwordx4 v14, s[28:31], s61 offen offset:2048 nt lds
  buffer_load_dwordx4 v15, s[28:31], s61 offen offset:3072 nt lds
  s_waitcnt vmcnt(8)
  s_add_u32 m0, s64, 28672
  s_add_u32 s61, s65, 126976
  s_and_b32 s61, s61, 0x1ffff
  buffer_load_dwordx4 v12, s[28:31], s61 offen offset:0 nt lds
  buffer_load_dwordx4 v13, s[28:31], s61 offen offset:1024 nt lds
  s_waitcnt vmcnt(8)
  buffer_load_dwordx4 v14, s[28:31], s61 offen offset:2048 nt lds
  buffer_load_dwordx4 v15, s[28:31], s61 offen offset:3072 nt lds
  s_waitcnt vmcnt(8)
  s_add_u32 m0, s64, 16384
  s_add_u32 s61, s65, 32768
  s_and_b32 s61, s61, 0x1ffff
  buffer_load_dwordx4 v12, s[32:35], s61 offen offset:0 nt lds
  buffer_load_dwordx4 v13, s[32:35], s61 offen offset:1024 nt lds
  ds_read_b128 v[32:35], v16 offset:8192
  ds_read_b128 v[36:39], v17 offset:8192
  ds_read_b128 v[40:43], v18 offset:8192
  ds_read_b128 v[44:47], v19 offset:8192
  ds_read_b128 v[48:51], v16 offset:8448
  ds_read_b128 v[52:55], v17 offset:8448
  ds_read_b128 v[56:59], v18 offset:8448
  ds_read_b128 v[60:63], v19 offset:8448
  v_max3_f32 v30, v30, v116, v117
  v_max3_f32 v30, v30, v118, v119
  s_waitcnt lgkmcnt(7)
  v_mfma_f32_16x16x32_bf16 v[120:123], v[32:35], v[128:131], 0
  s_waitcnt lgkmcnt(6)
  v_mfma_f32_16x16x32_bf16 v[120:123], v[36:39], v[132:135], v[120:123]
  s_waitcnt lgkmcnt(5)
  v_mfma_f32_16x16x32_bf16 v[120:123], v[40:43], v[136:139], v[120:123]
  s_waitcnt lgkmcnt(4)
  v_mfma_f32_16x16x32_bf16 v[120:123], v[44:47], v[140:143], v[120:123]
  s_waitcnt lgkmcnt(3)
  v_mfma_f32_16x16x32_bf16 v[120:123], v[48:51], v[144:147], v[120:123]
  s_waitcnt lgkmcnt(2)
  v_mfma_f32_16x16x32_bf16 v[120:123], v[52:55], v[148:151], v[120:123]
  s_waitcnt lgkmcnt(1)
  v_mfma_f32_16x16x32_bf16 v[120:123], v[56:59], v[152:155], v[120:123]
  s_waitcnt lgkmcnt(0)
  v_mfma_f32_16x16x32_bf16 v[120:123], v[60:63], v[156:159], v[120:123]
  s_waitcnt vmcnt(8)
  buffer_load_dwordx4 v14, s[32:35], s61 offen offset:2048 nt lds
  buffer_load_dwordx4 v15, s[32:35], s61 offen offset:3072 nt lds
  s_waitcnt vmcnt(8)
  s_add_u32 m0, s64, 20480
  s_add_u32 s61, s65, 36864
  s_and_b32 s61, s61, 0x1ffff
  buffer_load_dwordx4 v12, s[32:35], s61 offen offset:0 nt lds
  buffer_load_dwordx4 v13, s[32:35], s61 offen offset:1024 nt lds
  s_waitcnt vmcnt(8)
  buffer_load_dwordx4 v14, s[32:35], s61 offen offset:2048 nt lds
  buffer_load_dwordx4 v15, s[32:35], s61 offen offset:3072 nt lds
  s_waitcnt vmcnt(8)
  s_add_u32 m0, s64, 0
  s_add_u32 s61, s65, 24576
  s_and_b32 s61, s61, 0x1ffff
  buffer_load_dwordx4 v12, s[32:35], s61 offen offset:0 nt lds
  buffer_load_dwordx4 v13, s[32:35], s61 offen offset:1024 nt lds
  ds_read_b128 v[32:35], v16 offset:24576
  ds_read_b128 v[36:39], v17 offset:24576
  ds_read_b128 v[40:43], v18 offset:24576
  ds_read_b128 v[44:47], v19 offset:24576
  ds_read_b128 v[48:51], v16 offset:24832
  ds_read_b128 v[52:55], v17 offset:24832
  ds_read_b128 v[56:59], v18 offset:24832
  ds_read_b128 v[60:63], v19 offset:24832
  v_max3_f32 v30, v30, v120, v121
  v_max3_f32 v30, v30, v122, v123
  s_waitcnt lgkmcnt(7)
  v_mfma_f32_16x16x32_bf16 v[124:127], v[32:35], v[128:131], 0
  s_waitcnt lgkmcnt(6)
  v_mfma_f32_16x16x32_bf16 v[124:127], v[36:39], v[132:135], v[124:127]
  s_waitcnt lgkmcnt(5)
  v_mfma_f32_16x16x32_bf16 v[124:127], v[40:43], v[136:139], v[124:127]
  s_waitcnt lgkmcnt(4)
  v_mfma_f32_16x16x32_bf16 v[124:127], v[44:47], v[140:143], v[124:127]
  s_waitcnt lgkmcnt(3)
  v_mfma_f32_16x16x32_bf16 v[124:127], v[48:51], v[144:147], v[124:127]
  s_waitcnt lgkmcnt(2)
  v_mfma_f32_16x16x32_bf16 v[124:127], v[52:55], v[148:151], v[124:127]
  s_waitcnt lgkmcnt(1)
  v_mfma_f32_16x16x32_bf16 v[124:127], v[56:59], v[152:155], v[124:127]
  s_waitcnt lgkmcnt(0)
  v_mfma_f32_16x16x32_bf16 v[124:127], v[60:63], v[156:159], v[124:127]
  s_nop 7
  s_nop 1
  v_max3_f32 v30, v30, v124, v125
  v_max3_f32 v30, v30, v126, v127
  v_lshlrev_b32 v4, 2, v1
  v_xor_b32 v5, 64, v4
  ds_bpermute_b32 v6, v5, v30
  s_waitcnt lgkmcnt(0)
  v_max_f32 v30, v30, v6
  v_xor_b32 v5, 128, v4
  ds_bpermute_b32 v6, v5, v30
  s_waitcnt lgkmcnt(0)
  v_max_f32 v30, v30, v6
  v_mul_f32 v30, s72, v30
  v_and_b32 v5, 1, v2
  v_lshlrev_b32 v5, 4, v5
  s_lshl_b32 s66, s3, 2
  s_add_u32 s66, s66, 160768
  v_add_u32 v6, s66, v5
  ds_write_b32 v6, v30
  s_waitcnt vmcnt(8)
  buffer_load_dwordx4 v14, s[32:35], s61 offen offset:2048 nt lds
  buffer_load_dwordx4 v15, s[32:35], s61 offen offset:3072 nt lds
  s_waitcnt vmcnt(8)
  s_add_u32 m0, s64, 4096
  s_add_u32 s61, s65, 28672
  s_and_b32 s61, s61, 0x1ffff
  buffer_load_dwordx4 v12, s[32:35], s61 offen offset:0 nt lds
  buffer_load_dwordx4 v13, s[32:35], s61 offen offset:1024 nt lds
  s_waitcnt vmcnt(8)
  buffer_load_dwordx4 v14, s[32:35], s61 offen offset:2048 nt lds
  buffer_load_dwordx4 v15, s[32:35], s61 offen offset:3072 nt lds
  s_waitcnt vmcnt(8)
  s_add_u32 m0, s64, 8192
  s_add_u32 s61, s65, 40960
  s_and_b32 s61, s61, 0x1ffff
  buffer_load_dwordx4 v12, s[32:35], s61 offen offset:0 nt lds
  buffer_load_dwordx4 v13, s[32:35], s61 offen offset:1024 nt lds
  ds_read_b64_tr_b16 v[32:33], v20 offset:16384
  ds_read_b64_tr_b16 v[34:35], v21 offset:16384
  ds_read_b64_tr_b16 v[36:37], v22 offset:16384
  ds_read_b64_tr_b16 v[38:39], v23 offset:16384
  ds_read_b64_tr_b16 v[40:41], v24 offset:16384
  ds_read_b64_tr_b16 v[42:43], v25 offset:16384
  ds_read_b64_tr_b16 v[44:45], v26 offset:16384
  ds_read_b64_tr_b16 v[46:47], v27 offset:16384
  ds_read_b64_tr_b16 v[48:49], v20 offset:16640
  ds_read_b64_tr_b16 v[50:51], v21 offset:16640
  ds_read_b64_tr_b16 v[52:53], v22 offset:16640
  ds_read_b64_tr_b16 v[54:55], v23 offset:16640
  ds_read_b64_tr_b16 v[56:57], v24 offset:16640
  ds_read_b64_tr_b16 v[58:59], v25 offset:16640
  ds_read_b64_tr_b16 v[60:61], v26 offset:16640
  ds_read_b64_tr_b16 v[62:63], v27 offset:16640
  v_fma_f32 v64, v64, s72, -v30
  v_fma_f32 v65, v65, s72, -v30
  v_fma_f32 v66, v66, s72, -v30
  v_fma_f32 v67, v67, s72, -v30
  v_exp_f32 v64, v64
  v_exp_f32 v65, v65
  v_exp_f32 v66, v66
  v_exp_f32 v67, v67
  s_nop 0
  v_cvt_pk_bf16_f32 v128, v64, v65
  v_cvt_pk_bf16_f32 v129, v66, v67
  v_add_f32 v4, v64, v65
  v_add_f32 v5, v66, v67
  v_add_f32 v31, v31, v4
  v_add_f32 v31, v31, v5
  v_fma_f32 v68, v68, s72, -v30
  v_fma_f32 v69, v69, s72, -v30
  v_fma_f32 v70, v70, s72, -v30
  v_fma_f32 v71, v71, s72, -v30
  v_exp_f32 v68, v68
  v_exp_f32 v69, v69
  v_exp_f32 v70, v70
  v_exp_f32 v71, v71
  s_nop 0
  v_cvt_pk_bf16_f32 v130, v68, v69
  v_cvt_pk_bf16_f32 v131, v70, v71
  v_add_f32 v4, v68, v69
  v_add_f32 v5, v70, v71
  v_add_f32 v31, v31, v4
  v_add_f32 v31, v31, v5
  s_waitcnt lgkmcnt(14)
  v_mfma_f32_16x16x16_bf16 v[192:195], v[32:33], v[128:129], 0
  v_mfma_f32_16x16x16_bf16 v[196:199], v[34:35], v[128:129], 0
  s_waitcnt lgkmcnt(12)
  v_mfma_f32_16x16x16_bf16 v[200:203], v[36:37], v[128:129], 0
  v_mfma_f32_16x16x16_bf16 v[204:207], v[38:39], v[128:129], 0
  s_waitcnt lgkmcnt(10)
  v_mfma_f32_16x16x16_bf16 v[208:211], v[40:41], v[128:129], 0
  v_mfma_f32_16x16x16_bf16 v[212:215], v[42:43], v[128:129], 0
  s_waitcnt lgkmcnt(8)
  v_mfma_f32_16x16x16_bf16 v[216:219], v[44:45], v[128:129], 0
  v_mfma_f32_16x16x16_bf16 v[220:223], v[46:47], v[128:129], 0
  s_waitcnt lgkmcnt(6)
  v_mfma_f32_16x16x16_bf16 v[224:227], v[48:49], v[128:129], 0
  v_mfma_f32_16x16x16_bf16 v[228:231], v[50:51], v[128:129], 0
  s_waitcnt lgkmcnt(4)
  v_mfma_f32_16x16x16_bf16 v[232:235], v[52:53], v[128:129], 0
  v_mfma_f32_16x16x16_bf16 v[236:239], v[54:55], v[128:129], 0
  s_waitcnt lgkmcnt(2)
  v_mfma_f32_16x16x16_bf16 v[240:243], v[56:57], v[128:129], 0
  v_mfma_f32_16x16x16_bf16 v[244:247], v[58:59], v[128:129], 0
  s_waitcnt lgkmcnt(0)
  v_mfma_f32_16x16x16_bf16 v[248:251], v[60:61], v[128:129], 0
  v_mfma_f32_16x16x16_bf16 v[252:255], v[62:63], v[128:129], 0
  s_waitcnt vmcnt(8)
  buffer_load_dwordx4 v14, s[32:35], s61 offen offset:2048 nt lds
  buffer_load_dwordx4 v15, s[32:35], s61 offen offset:3072 nt lds
  s_waitcnt vmcnt(8)
  s_add_u32 m0, s64, 12288
  s_add_u32 s61, s65, 45056
  s_and_b32 s61, s61, 0x1ffff
  buffer_load_dwordx4 v12, s[32:35], s61 offen offset:0 nt lds
  buffer_load_dwordx4 v13, s[32:35], s61 offen offset:1024 nt lds
  s_waitcnt vmcnt(8)
  buffer_load_dwordx4 v14, s[32:35], s61 offen offset:2048 nt lds
  buffer_load_dwordx4 v15, s[32:35], s61 offen offset:3072 nt lds
  s_waitcnt vmcnt(8)
  s_add_u32 m0, s64, 24576
  s_add_u32 s61, s65, 49152
  s_and_b32 s61, s61, 0x1ffff
  buffer_load_dwordx4 v12, s[32:35], s61 offen offset:0 nt lds
  buffer_load_dwordx4 v13, s[32:35], s61 offen offset:1024 nt lds
  ds_read_b64_tr_b16 v[32:33], v20 offset:0
  ds_read_b64_tr_b16 v[34:35], v21 offset:0
  ds_read_b64_tr_b16 v[36:37], v22 offset:0
  ds_read_b64_tr_b16 v[38:39], v23 offset:0
  ds_read_b64_tr_b16 v[40:41], v24 offset:0
  ds_read_b64_tr_b16 v[42:43], v25 offset:0
  ds_read_b64_tr_b16 v[44:45], v26 offset:0
  ds_read_b64_tr_b16 v[46:47], v27 offset:0
  ds_read_b64_tr_b16 v[48:49], v20 offset:256
  ds_read_b64_tr_b16 v[50:51], v21 offset:256
  ds_read_b64_tr_b16 v[52:53], v22 offset:256
  ds_read_b64_tr_b16 v[54:55], v23 offset:256
  ds_read_b64_tr_b16 v[56:57], v24 offset:256
  ds_read_b64_tr_b16 v[58:59], v25 offset:256
  ds_read_b64_tr_b16 v[60:61], v26 offset:256
  ds_read_b64_tr_b16 v[62:63], v27 offset:256
  v_fma_f32 v72, v72, s72, -v30
  v_fma_f32 v73, v73, s72, -v30
  v_fma_f32 v74, v74, s72, -v30
  v_fma_f32 v75, v75, s72, -v30
  v_exp_f32 v72, v72
  v_exp_f32 v73, v73
  v_exp_f32 v74, v74
  v_exp_f32 v75, v75
  s_nop 0
  v_cvt_pk_bf16_f32 v132, v72, v73
  v_cvt_pk_bf16_f32 v133, v74, v75
  v_add_f32 v4, v72, v73
  v_add_f32 v5, v74, v75
  v_add_f32 v31, v31, v4
  v_add_f32 v31, v31, v5
  v_fma_f32 v76, v76, s72, -v30
  v_fma_f32 v77, v77, s72, -v30
  v_fma_f32 v78, v78, s72, -v30
  v_fma_f32 v79, v79, s72, -v30
  v_exp_f32 v76, v76
  v_exp_f32 v77, v77
  v_exp_f32 v78, v78
  v_exp_f32 v79, v79
  s_nop 0
  v_cvt_pk_bf16_f32 v134, v76, v77
  v_cvt_pk_bf16_f32 v135, v78, v79
  v_add_f32 v4, v76, v77
  v_add_f32 v5, v78, v79
  v_add_f32 v31, v31, v4
  v_add_f32 v31, v31, v5
  s_waitcnt lgkmcnt(14)
  v_mfma_f32_16x16x16_bf16 v[192:195], v[32:33], v[130:131], v[192:195]
  v_mfma_f32_16x16x16_bf16 v[196:199], v[34:35], v[130:131], v[196:199]
  s_waitcnt lgkmcnt(12)
  v_mfma_f32_16x16x16_bf16 v[200:203], v[36:37], v[130:131], v[200:203]
  v_mfma_f32_16x16x16_bf16 v[204:207], v[38:39], v[130:131], v[204:207]
  s_waitcnt lgkmcnt(10)
  v_mfma_f32_16x16x16_bf16 v[208:211], v[40:41], v[130:131], v[208:211]
  v_mfma_f32_16x16x16_bf16 v[212:215], v[42:43], v[130:131], v[212:215]
  s_waitcnt lgkmcnt(8)
  v_mfma_f32_16x16x16_bf16 v[216:219], v[44:45], v[130:131], v[216:219]
  v_mfma_f32_16x16x16_bf16 v[220:223], v[46:47], v[130:131], v[220:223]
  s_waitcnt lgkmcnt(6)
  v_mfma_f32_16x16x16_bf16 v[224:227], v[48:49], v[130:131], v[224:227]
  v_mfma_f32_16x16x16_bf16 v[228:231], v[50:51], v[130:131], v[228:231]
  s_waitcnt lgkmcnt(4)
  v_mfma_f32_16x16x16_bf16 v[232:235], v[52:53], v[130:131], v[232:235]
  v_mfma_f32_16x16x16_bf16 v[236:239], v[54:55], v[130:131], v[236:239]
  s_waitcnt lgkmcnt(2)
  v_mfma_f32_16x16x16_bf16 v[240:243], v[56:57], v[130:131], v[240:243]
  v_mfma_f32_16x16x16_bf16 v[244:247], v[58:59], v[130:131], v[244:247]
  s_waitcnt lgkmcnt(0)
  v_mfma_f32_16x16x16_bf16 v[248:251], v[60:61], v[130:131], v[248:251]
  v_mfma_f32_16x16x16_bf16 v[252:255], v[62:63], v[130:131], v[252:255]
  s_waitcnt vmcnt(8)
  buffer_load_dwordx4 v14, s[32:35], s61 offen offset:2048 nt lds
  buffer_load_dwordx4 v15, s[32:35], s61 offen offset:3072 nt lds
  s_waitcnt vmcnt(8)
  s_add_u32 m0, s64, 28672
  s_add_u32 s61, s65, 53248
  s_and_b32 s61, s61, 0x1ffff
  buffer_load_dwordx4 v12, s[32:35], s61 offen offset:0 nt lds
  buffer_load_dwordx4 v13, s[32:35], s61 offen offset:1024 nt lds
  s_waitcnt vmcnt(8)
  buffer_load_dwordx4 v14, s[32:35], s61 offen offset:2048 nt lds
  buffer_load_dwordx4 v15, s[32:35], s61 offen offset:3072 nt lds
  s_waitcnt vmcnt(8)
  s_add_u32 m0, s64, 16384
  s_add_u32 s61, s65, 57344
  s_and_b32 s61, s61, 0x1ffff
  buffer_load_dwordx4 v12, s[32:35], s61 offen offset:0 nt lds
  buffer_load_dwordx4 v13, s[32:35], s61 offen offset:1024 nt lds
  ds_read_b64_tr_b16 v[32:33], v20 offset:8192
  ds_read_b64_tr_b16 v[34:35], v21 offset:8192
  ds_read_b64_tr_b16 v[36:37], v22 offset:8192
  ds_read_b64_tr_b16 v[38:39], v23 offset:8192
  ds_read_b64_tr_b16 v[40:41], v24 offset:8192
  ds_read_b64_tr_b16 v[42:43], v25 offset:8192
  ds_read_b64_tr_b16 v[44:45], v26 offset:8192
  ds_read_b64_tr_b16 v[46:47], v27 offset:8192
  ds_read_b64_tr_b16 v[48:49], v20 offset:8448
  ds_read_b64_tr_b16 v[50:51], v21 offset:8448
  ds_read_b64_tr_b16 v[52:53], v22 offset:8448
  ds_read_b64_tr_b16 v[54:55], v23 offset:8448
  ds_read_b64_tr_b16 v[56:57], v24 offset:8448
  ds_read_b64_tr_b16 v[58:59], v25 offset:8448
  ds_read_b64_tr_b16 v[60:61], v26 offset:8448
  ds_read_b64_tr_b16 v[62:63], v27 offset:8448
  v_fma_f32 v80, v80, s72, -v30
  v_fma_f32 v81, v81, s72, -v30
  v_fma_f32 v82, v82, s72, -v30
  v_fma_f32 v83, v83, s72, -v30
  v_exp_f32 v80, v80
  v_exp_f32 v81, v81
  v_exp_f32 v82, v82
  v_exp_f32 v83, v83
  s_nop 0
  v_cvt_pk_bf16_f32 v136, v80, v81
  v_cvt_pk_bf16_f32 v137, v82, v83
  v_add_f32 v4, v80, v81
  v_add_f32 v5, v82, v83
  v_add_f32 v31, v31, v4
  v_add_f32 v31, v31, v5
  v_fma_f32 v84, v84, s72, -v30
  v_fma_f32 v85, v85, s72, -v30
  v_fma_f32 v86, v86, s72, -v30
  v_fma_f32 v87, v87, s72, -v30
  v_exp_f32 v84, v84
  v_exp_f32 v85, v85
  v_exp_f32 v86, v86
  v_exp_f32 v87, v87
  s_nop 0
  v_cvt_pk_bf16_f32 v138, v84, v85
  v_cvt_pk_bf16_f32 v139, v86, v87
  v_add_f32 v4, v84, v85
  v_add_f32 v5, v86, v87
  v_add_f32 v31, v31, v4
  v_add_f32 v31, v31, v5
  s_waitcnt lgkmcnt(14)
  v_mfma_f32_16x16x16_bf16 v[192:195], v[32:33], v[132:133], v[192:195]
  v_mfma_f32_16x16x16_bf16 v[196:199], v[34:35], v[132:133], v[196:199]
  s_waitcnt lgkmcnt(12)
  v_mfma_f32_16x16x16_bf16 v[200:203], v[36:37], v[132:133], v[200:203]
  v_mfma_f32_16x16x16_bf16 v[204:207], v[38:39], v[132:133], v[204:207]
  s_waitcnt lgkmcnt(10)
  v_mfma_f32_16x16x16_bf16 v[208:211], v[40:41], v[132:133], v[208:211]
  v_mfma_f32_16x16x16_bf16 v[212:215], v[42:43], v[132:133], v[212:215]
  s_waitcnt lgkmcnt(8)
  v_mfma_f32_16x16x16_bf16 v[216:219], v[44:45], v[132:133], v[216:219]
  v_mfma_f32_16x16x16_bf16 v[220:223], v[46:47], v[132:133], v[220:223]
  s_waitcnt lgkmcnt(6)
  v_mfma_f32_16x16x16_bf16 v[224:227], v[48:49], v[132:133], v[224:227]
  v_mfma_f32_16x16x16_bf16 v[228:231], v[50:51], v[132:133], v[228:231]
  s_waitcnt lgkmcnt(4)
  v_mfma_f32_16x16x16_bf16 v[232:235], v[52:53], v[132:133], v[232:235]
  v_mfma_f32_16x16x16_bf16 v[236:239], v[54:55], v[132:133], v[236:239]
  s_waitcnt lgkmcnt(2)
  v_mfma_f32_16x16x16_bf16 v[240:243], v[56:57], v[132:133], v[240:243]
  v_mfma_f32_16x16x16_bf16 v[244:247], v[58:59], v[132:133], v[244:247]
  s_waitcnt lgkmcnt(0)
  v_mfma_f32_16x16x16_bf16 v[248:251], v[60:61], v[132:133], v[248:251]
  v_mfma_f32_16x16x16_bf16 v[252:255], v[62:63], v[132:133], v[252:255]
  s_waitcnt vmcnt(8)
  buffer_load_dwordx4 v14, s[32:35], s61 offen offset:2048 nt lds
  buffer_load_dwordx4 v15, s[32:35], s61 offen offset:3072 nt lds
  s_waitcnt vmcnt(8)
  s_add_u32 m0, s64, 20480
  s_add_u32 s61, s65, 61440
  s_and_b32 s61, s61, 0x1ffff
  buffer_load_dwordx4 v12, s[32:35], s61 offen offset:0 nt lds
  buffer_load_dwordx4 v13, s[32:35], s61 offen offset:1024 nt lds
  s_waitcnt vmcnt(8)
  buffer_load_dwordx4 v14, s[32:35], s61 offen offset:2048 nt lds
  buffer_load_dwordx4 v15, s[32:35], s61 offen offset:3072 nt lds
  s_waitcnt vmcnt(8)
  s_add_u32 m0, s64, 0
  s_nop 0
  buffer_load_dwordx4 v12, s[32:35], s65 offen offset:0 nt lds
  buffer_load_dwordx4 v13, s[32:35], s65 offen offset:1024 nt lds
  ds_read_b64_tr_b16 v[32:33], v20 offset:24576
  ds_read_b64_tr_b16 v[34:35], v21 offset:24576
  ds_read_b64_tr_b16 v[36:37], v22 offset:24576
  ds_read_b64_tr_b16 v[38:39], v23 offset:24576
  ds_read_b64_tr_b16 v[40:41], v24 offset:24576
  ds_read_b64_tr_b16 v[42:43], v25 offset:24576
  ds_read_b64_tr_b16 v[44:45], v26 offset:24576
  ds_read_b64_tr_b16 v[46:47], v27 offset:24576
  ds_read_b64_tr_b16 v[48:49], v20 offset:24832
  ds_read_b64_tr_b16 v[50:51], v21 offset:24832
  ds_read_b64_tr_b16 v[52:53], v22 offset:24832
  ds_read_b64_tr_b16 v[54:55], v23 offset:24832
  ds_read_b64_tr_b16 v[56:57], v24 offset:24832
  ds_read_b64_tr_b16 v[58:59], v25 offset:24832
  ds_read_b64_tr_b16 v[60:61], v26 offset:24832
  ds_read_b64_tr_b16 v[62:63], v27 offset:24832
  v_fma_f32 v88, v88, s72, -v30
  v_fma_f32 v89, v89, s72, -v30
  v_fma_f32 v90, v90, s72, -v30
  v_fma_f32 v91, v91, s72, -v30
  v_exp_f32 v88, v88
  v_exp_f32 v89, v89
  v_exp_f32 v90, v90
  v_exp_f32 v91, v91
  s_nop 0
  v_cvt_pk_bf16_f32 v140, v88, v89
  v_cvt_pk_bf16_f32 v141, v90, v91
  v_add_f32 v4, v88, v89
  v_add_f32 v5, v90, v91
  v_add_f32 v31, v31, v4
  v_add_f32 v31, v31, v5
  v_fma_f32 v92, v92, s72, -v30
  v_fma_f32 v93, v93, s72, -v30
  v_fma_f32 v94, v94, s72, -v30
  v_fma_f32 v95, v95, s72, -v30
  v_exp_f32 v92, v92
  v_exp_f32 v93, v93
  v_exp_f32 v94, v94
  v_exp_f32 v95, v95
  s_nop 0
  v_cvt_pk_bf16_f32 v142, v92, v93
  v_cvt_pk_bf16_f32 v143, v94, v95
  v_add_f32 v4, v92, v93
  v_add_f32 v5, v94, v95
  v_add_f32 v31, v31, v4
  v_add_f32 v31, v31, v5
  s_waitcnt lgkmcnt(14)
  v_mfma_f32_16x16x16_bf16 v[192:195], v[32:33], v[134:135], v[192:195]
  v_mfma_f32_16x16x16_bf16 v[196:199], v[34:35], v[134:135], v[196:199]
  s_waitcnt lgkmcnt(12)
  v_mfma_f32_16x16x16_bf16 v[200:203], v[36:37], v[134:135], v[200:203]
  v_mfma_f32_16x16x16_bf16 v[204:207], v[38:39], v[134:135], v[204:207]
  s_waitcnt lgkmcnt(10)
  v_mfma_f32_16x16x16_bf16 v[208:211], v[40:41], v[134:135], v[208:211]
  v_mfma_f32_16x16x16_bf16 v[212:215], v[42:43], v[134:135], v[212:215]
  s_waitcnt lgkmcnt(8)
  v_mfma_f32_16x16x16_bf16 v[216:219], v[44:45], v[134:135], v[216:219]
  v_mfma_f32_16x16x16_bf16 v[220:223], v[46:47], v[134:135], v[220:223]
  s_waitcnt lgkmcnt(6)
  v_mfma_f32_16x16x16_bf16 v[224:227], v[48:49], v[134:135], v[224:227]
  v_mfma_f32_16x16x16_bf16 v[228:231], v[50:51], v[134:135], v[228:231]
  s_waitcnt lgkmcnt(4)
  v_mfma_f32_16x16x16_bf16 v[232:235], v[52:53], v[134:135], v[232:235]
  v_mfma_f32_16x16x16_bf16 v[236:239], v[54:55], v[134:135], v[236:239]
  s_waitcnt lgkmcnt(2)
  v_mfma_f32_16x16x16_bf16 v[240:243], v[56:57], v[134:135], v[240:243]
  v_mfma_f32_16x16x16_bf16 v[244:247], v[58:59], v[134:135], v[244:247]
  s_waitcnt lgkmcnt(0)
  v_mfma_f32_16x16x16_bf16 v[248:251], v[60:61], v[134:135], v[248:251]
  v_mfma_f32_16x16x16_bf16 v[252:255], v[62:63], v[134:135], v[252:255]
  s_waitcnt vmcnt(8)
  buffer_load_dwordx4 v14, s[32:35], s65 offen offset:2048 nt lds
  buffer_load_dwordx4 v15, s[32:35], s65 offen offset:3072 nt lds
  s_waitcnt vmcnt(8)
  s_add_u32 m0, s64, 4096
  s_add_u32 s61, s65, 4096
  s_and_b32 s61, s61, 0x1ffff
  buffer_load_dwordx4 v12, s[32:35], s61 offen offset:0 nt lds
  buffer_load_dwordx4 v13, s[32:35], s61 offen offset:1024 nt lds
  s_waitcnt vmcnt(8)
  buffer_load_dwordx4 v14, s[32:35], s61 offen offset:2048 nt lds
  buffer_load_dwordx4 v15, s[32:35], s61 offen offset:3072 nt lds
  s_waitcnt vmcnt(8)
  s_add_u32 m0, s64, 8192
  s_add_u32 s61, s65, 8192
  s_and_b32 s61, s61, 0x1ffff
  buffer_load_dwordx4 v12, s[32:35], s61 offen offset:0 nt lds
  buffer_load_dwordx4 v13, s[32:35], s61 offen offset:1024 nt lds
  ds_read_b64_tr_b16 v[32:33], v20 offset:16384
  ds_read_b64_tr_b16 v[34:35], v21 offset:16384
  ds_read_b64_tr_b16 v[36:37], v22 offset:16384
  ds_read_b64_tr_b16 v[38:39], v23 offset:16384
  ds_read_b64_tr_b16 v[40:41], v24 offset:16384
  ds_read_b64_tr_b16 v[42:43], v25 offset:16384
  ds_read_b64_tr_b16 v[44:45], v26 offset:16384
  ds_read_b64_tr_b16 v[46:47], v27 offset:16384
  ds_read_b64_tr_b16 v[48:49], v20 offset:16640
  ds_read_b64_tr_b16 v[50:51], v21 offset:16640
  ds_read_b64_tr_b16 v[52:53], v22 offset:16640
  ds_read_b64_tr_b16 v[54:55], v23 offset:16640
  ds_read_b64_tr_b16 v[56:57], v24 offset:16640
  ds_read_b64_tr_b16 v[58:59], v25 offset:16640
  ds_read_b64_tr_b16 v[60:61], v26 offset:16640
  ds_read_b64_tr_b16 v[62:63], v27 offset:16640
  v_fma_f32 v96, v96, s72, -v30
  v_fma_f32 v97, v97, s72, -v30
  v_fma_f32 v98, v98, s72, -v30
  v_fma_f32 v99, v99, s72, -v30
  v_exp_f32 v96, v96
  v_exp_f32 v97, v97
  v_exp_f32 v98, v98
  v_exp_f32 v99, v99
  s_nop 0
  v_cvt_pk_bf16_f32 v144, v96, v97
  v_cvt_pk_bf16_f32 v145, v98, v99
  v_add_f32 v4, v96, v97
  v_add_f32 v5, v98, v99
  v_add_f32 v31, v31, v4
  v_add_f32 v31, v31, v5
  v_fma_f32 v100, v100, s72, -v30
  v_fma_f32 v101, v101, s72, -v30
  v_fma_f32 v102, v102, s72, -v30
  v_fma_f32 v103, v103, s72, -v30
  v_exp_f32 v100, v100
  v_exp_f32 v101, v101
  v_exp_f32 v102, v102
  v_exp_f32 v103, v103
  s_nop 0
  v_cvt_pk_bf16_f32 v146, v100, v101
  v_cvt_pk_bf16_f32 v147, v102, v103
  v_add_f32 v4, v100, v101
  v_add_f32 v5, v102, v103
  v_add_f32 v31, v31, v4
  v_add_f32 v31, v31, v5
  s_waitcnt lgkmcnt(14)
  v_mfma_f32_16x16x16_bf16 v[192:195], v[32:33], v[136:137], v[192:195]
  v_mfma_f32_16x16x16_bf16 v[196:199], v[34:35], v[136:137], v[196:199]
  s_waitcnt lgkmcnt(12)
  v_mfma_f32_16x16x16_bf16 v[200:203], v[36:37], v[136:137], v[200:203]
  v_mfma_f32_16x16x16_bf16 v[204:207], v[38:39], v[136:137], v[204:207]
  s_waitcnt lgkmcnt(10)
  v_mfma_f32_16x16x16_bf16 v[208:211], v[40:41], v[136:137], v[208:211]
  v_mfma_f32_16x16x16_bf16 v[212:215], v[42:43], v[136:137], v[212:215]
  s_waitcnt lgkmcnt(8)
  v_mfma_f32_16x16x16_bf16 v[216:219], v[44:45], v[136:137], v[216:219]
  v_mfma_f32_16x16x16_bf16 v[220:223], v[46:47], v[136:137], v[220:223]
  s_waitcnt lgkmcnt(6)
  v_mfma_f32_16x16x16_bf16 v[224:227], v[48:49], v[136:137], v[224:227]
  v_mfma_f32_16x16x16_bf16 v[228:231], v[50:51], v[136:137], v[228:231]
  s_waitcnt lgkmcnt(4)
  v_mfma_f32_16x16x16_bf16 v[232:235], v[52:53], v[136:137], v[232:235]
  v_mfma_f32_16x16x16_bf16 v[236:239], v[54:55], v[136:137], v[236:239]
  s_waitcnt lgkmcnt(2)
  v_mfma_f32_16x16x16_bf16 v[240:243], v[56:57], v[136:137], v[240:243]
  v_mfma_f32_16x16x16_bf16 v[244:247], v[58:59], v[136:137], v[244:247]
  s_waitcnt lgkmcnt(0)
  v_mfma_f32_16x16x16_bf16 v[248:251], v[60:61], v[136:137], v[248:251]
  v_mfma_f32_16x16x16_bf16 v[252:255], v[62:63], v[136:137], v[252:255]
  s_waitcnt vmcnt(8)
  buffer_load_dwordx4 v14, s[32:35], s61 offen offset:2048 nt lds
  buffer_load_dwordx4 v15, s[32:35], s61 offen offset:3072 nt lds
  s_waitcnt vmcnt(8)
  s_add_u32 m0, s64, 12288
  s_add_u32 s61, s65, 12288
  s_and_b32 s61, s61, 0x1ffff
  buffer_load_dwordx4 v12, s[32:35], s61 offen offset:0 nt lds
  buffer_load_dwordx4 v13, s[32:35], s61 offen offset:1024 nt lds
  s_waitcnt vmcnt(8)
  buffer_load_dwordx4 v14, s[32:35], s61 offen offset:2048 nt lds
  buffer_load_dwordx4 v15, s[32:35], s61 offen offset:3072 nt lds
  s_waitcnt vmcnt(8)
  s_add_u32 m0, s64, 24576
  s_add_u32 s61, s65, 16384
  s_and_b32 s61, s61, 0x1ffff
  buffer_load_dwordx4 v12, s[32:35], s61 offen offset:0 nt lds
  buffer_load_dwordx4 v13, s[32:35], s61 offen offset:1024 nt lds
  ds_read_b64_tr_b16 v[32:33], v20 offset:0
  ds_read_b64_tr_b16 v[34:35], v21 offset:0
  ds_read_b64_tr_b16 v[36:37], v22 offset:0
  ds_read_b64_tr_b16 v[38:39], v23 offset:0
  ds_read_b64_tr_b16 v[40:41], v24 offset:0
  ds_read_b64_tr_b16 v[42:43], v25 offset:0
  ds_read_b64_tr_b16 v[44:45], v26 offset:0
  ds_read_b64_tr_b16 v[46:47], v27 offset:0
  ds_read_b64_tr_b16 v[48:49], v20 offset:256
  ds_read_b64_tr_b16 v[50:51], v21 offset:256
  ds_read_b64_tr_b16 v[52:53], v22 offset:256
  ds_read_b64_tr_b16 v[54:55], v23 offset:256
  ds_read_b64_tr_b16 v[56:57], v24 offset:256
  ds_read_b64_tr_b16 v[58:59], v25 offset:256
  ds_read_b64_tr_b16 v[60:61], v26 offset:256
  ds_read_b64_tr_b16 v[62:63], v27 offset:256
  v_fma_f32 v104, v104, s72, -v30
  v_fma_f32 v105, v105, s72, -v30
  v_fma_f32 v106, v106, s72, -v30
  v_fma_f32 v107, v107, s72, -v30
  v_exp_f32 v104, v104
  v_exp_f32 v105, v105
  v_exp_f32 v106, v106
  v_exp_f32 v107, v107
  s_nop 0
  v_cvt_pk_bf16_f32 v148, v104, v105
  v_cvt_pk_bf16_f32 v149, v106, v107
  v_add_f32 v4, v104, v105
  v_add_f32 v5, v106, v107
  v_add_f32 v31, v31, v4
  v_add_f32 v31, v31, v5
  v_fma_f32 v108, v108, s72, -v30
  v_fma_f32 v109, v109, s72, -v30
  v_fma_f32 v110, v110, s72, -v30
  v_fma_f32 v111, v111, s72, -v30
  v_exp_f32 v108, v108
  v_exp_f32 v109, v109
  v_exp_f32 v110, v110
  v_exp_f32 v111, v111
  s_nop 0
  v_cvt_pk_bf16_f32 v150, v108, v109
  v_cvt_pk_bf16_f32 v151, v110, v111
  v_add_f32 v4, v108, v109
  v_add_f32 v5, v110, v111
  v_add_f32 v31, v31, v4
  v_add_f32 v31, v31, v5
  s_waitcnt lgkmcnt(14)
  v_mfma_f32_16x16x16_bf16 v[192:195], v[32:33], v[138:139], v[192:195]
  v_mfma_f32_16x16x16_bf16 v[196:199], v[34:35], v[138:139], v[196:199]
  s_waitcnt lgkmcnt(12)
  v_mfma_f32_16x16x16_bf16 v[200:203], v[36:37], v[138:139], v[200:203]
  v_mfma_f32_16x16x16_bf16 v[204:207], v[38:39], v[138:139], v[204:207]
  s_waitcnt lgkmcnt(10)
  v_mfma_f32_16x16x16_bf16 v[208:211], v[40:41], v[138:139], v[208:211]
  v_mfma_f32_16x16x16_bf16 v[212:215], v[42:43], v[138:139], v[212:215]
  s_waitcnt lgkmcnt(8)
  v_mfma_f32_16x16x16_bf16 v[216:219], v[44:45], v[138:139], v[216:219]
  v_mfma_f32_16x16x16_bf16 v[220:223], v[46:47], v[138:139], v[220:223]
  s_waitcnt lgkmcnt(6)
  v_mfma_f32_16x16x16_bf16 v[224:227], v[48:49], v[138:139], v[224:227]
  v_mfma_f32_16x16x16_bf16 v[228:231], v[50:51], v[138:139], v[228:231]
  s_waitcnt lgkmcnt(4)
  v_mfma_f32_16x16x16_bf16 v[232:235], v[52:53], v[138:139], v[232:235]
  v_mfma_f32_16x16x16_bf16 v[236:239], v[54:55], v[138:139], v[236:239]
  s_waitcnt lgkmcnt(2)
  v_mfma_f32_16x16x16_bf16 v[240:243], v[56:57], v[138:139], v[240:243]
  v_mfma_f32_16x16x16_bf16 v[244:247], v[58:59], v[138:139], v[244:247]
  s_waitcnt lgkmcnt(0)
  v_mfma_f32_16x16x16_bf16 v[248:251], v[60:61], v[138:139], v[248:251]
  v_mfma_f32_16x16x16_bf16 v[252:255], v[62:63], v[138:139], v[252:255]
  s_waitcnt vmcnt(8)
  buffer_load_dwordx4 v14, s[32:35], s61 offen offset:2048 nt lds
  buffer_load_dwordx4 v15, s[32:35], s61 offen offset:3072 nt lds
  s_waitcnt vmcnt(8)
  s_add_u32 m0, s64, 28672
  s_add_u32 s61, s65, 20480
  s_and_b32 s61, s61, 0x1ffff
  buffer_load_dwordx4 v12, s[32:35], s61 offen offset:0 nt lds
  buffer_load_dwordx4 v13, s[32:35], s61 offen offset:1024 nt lds
  s_waitcnt vmcnt(8)
  buffer_load_dwordx4 v14, s[32:35], s61 offen offset:2048 nt lds
  buffer_load_dwordx4 v15, s[32:35], s61 offen offset:3072 nt lds
  s_waitcnt vmcnt(8)
  s_add_u32 m0, s64, 16384
  s_add_u32 s61, s65, 65536
  s_and_b32 s61, s61, 0x1ffff
  buffer_load_dwordx4 v12, s[32:35], s61 offen offset:0 nt lds
  buffer_load_dwordx4 v13, s[32:35], s61 offen offset:1024 nt lds
  ds_read_b64_tr_b16 v[32:33], v20 offset:8192
  ds_read_b64_tr_b16 v[34:35], v21 offset:8192
  ds_read_b64_tr_b16 v[36:37], v22 offset:8192
  ds_read_b64_tr_b16 v[38:39], v23 offset:8192
  ds_read_b64_tr_b16 v[40:41], v24 offset:8192
  ds_read_b64_tr_b16 v[42:43], v25 offset:8192
  ds_read_b64_tr_b16 v[44:45], v26 offset:8192
  ds_read_b64_tr_b16 v[46:47], v27 offset:8192
  ds_read_b64_tr_b16 v[48:49], v20 offset:8448
  ds_read_b64_tr_b16 v[50:51], v21 offset:8448
  ds_read_b64_tr_b16 v[52:53], v22 offset:8448
  ds_read_b64_tr_b16 v[54:55], v23 offset:8448
  ds_read_b64_tr_b16 v[56:57], v24 offset:8448
  ds_read_b64_tr_b16 v[58:59], v25 offset:8448
  ds_read_b64_tr_b16 v[60:61], v26 offset:8448
  ds_read_b64_tr_b16 v[62:63], v27 offset:8448
  v_fma_f32 v112, v112, s72, -v30
  v_fma_f32 v113, v113, s72, -v30
  v_fma_f32 v114, v114, s72, -v30
  v_fma_f32 v115, v115, s72, -v30
  v_exp_f32 v112, v112
  v_exp_f32 v113, v113
  v_exp_f32 v114, v114
  v_exp_f32 v115, v115
  s_nop 0
  v_cvt_pk_bf16_f32 v152, v112, v113
  v_cvt_pk_bf16_f32 v153, v114, v115
  v_add_f32 v4, v112, v113
  v_add_f32 v5, v114, v115
  v_add_f32 v31, v31, v4
  v_add_f32 v31, v31, v5
  v_fma_f32 v116, v116, s72, -v30
  v_fma_f32 v117, v117, s72, -v30
  v_fma_f32 v118, v118, s72, -v30
  v_fma_f32 v119, v119, s72, -v30
  v_exp_f32 v116, v116
  v_exp_f32 v117, v117
  v_exp_f32 v118, v118
  v_exp_f32 v119, v119
  s_nop 0
  v_cvt_pk_bf16_f32 v154, v116, v117
  v_cvt_pk_bf16_f32 v155, v118, v119
  v_add_f32 v4, v116, v117
  v_add_f32 v5, v118, v119
  v_add_f32 v31, v31, v4
  v_add_f32 v31, v31, v5
  s_waitcnt lgkmcnt(14)
  v_mfma_f32_16x16x16_bf16 v[192:195], v[32:33], v[140:141], v[192:195]
  v_mfma_f32_16x16x16_bf16 v[196:199], v[34:35], v[140:141], v[196:199]
  s_waitcnt lgkmcnt(12)
  v_mfma_f32_16x16x16_bf16 v[200:203], v[36:37], v[140:141], v[200:203]
  v_mfma_f32_16x16x16_bf16 v[204:207], v[38:39], v[140:141], v[204:207]
  s_waitcnt lgkmcnt(10)
  v_mfma_f32_16x16x16_bf16 v[208:211], v[40:41], v[140:141], v[208:211]
  v_mfma_f32_16x16x16_bf16 v[212:215], v[42:43], v[140:141], v[212:215]
  s_waitcnt lgkmcnt(8)
  v_mfma_f32_16x16x16_bf16 v[216:219], v[44:45], v[140:141], v[216:219]
  v_mfma_f32_16x16x16_bf16 v[220:223], v[46:47], v[140:141], v[220:223]
  s_waitcnt lgkmcnt(6)
  v_mfma_f32_16x16x16_bf16 v[224:227], v[48:49], v[140:141], v[224:227]
  v_mfma_f32_16x16x16_bf16 v[228:231], v[50:51], v[140:141], v[228:231]
  s_waitcnt lgkmcnt(4)
  v_mfma_f32_16x16x16_bf16 v[232:235], v[52:53], v[140:141], v[232:235]
  v_mfma_f32_16x16x16_bf16 v[236:239], v[54:55], v[140:141], v[236:239]
  s_waitcnt lgkmcnt(2)
  v_mfma_f32_16x16x16_bf16 v[240:243], v[56:57], v[140:141], v[240:243]
  v_mfma_f32_16x16x16_bf16 v[244:247], v[58:59], v[140:141], v[244:247]
  s_waitcnt lgkmcnt(0)
  v_mfma_f32_16x16x16_bf16 v[248:251], v[60:61], v[140:141], v[248:251]
  v_mfma_f32_16x16x16_bf16 v[252:255], v[62:63], v[140:141], v[252:255]
  s_waitcnt vmcnt(8)
  buffer_load_dwordx4 v14, s[32:35], s61 offen offset:2048 nt lds
  buffer_load_dwordx4 v15, s[32:35], s61 offen offset:3072 nt lds
  s_waitcnt vmcnt(8)
  s_add_u32 m0, s64, 20480
  s_add_u32 s61, s65, 69632
  s_and_b32 s61, s61, 0x1ffff
  buffer_load_dwordx4 v12, s[32:35], s61 offen offset:0 nt lds
  buffer_load_dwordx4 v13, s[32:35], s61 offen offset:1024 nt lds
  s_waitcnt vmcnt(8)
  buffer_load_dwordx4 v14, s[32:35], s61 offen offset:2048 nt lds
  buffer_load_dwordx4 v15, s[32:35], s61 offen offset:3072 nt lds
  s_waitcnt vmcnt(8)
  s_add_u32 m0, s64, 0
  s_add_u32 s61, s65, 73728
  s_and_b32 s61, s61, 0x1ffff
  buffer_load_dwordx4 v12, s[32:35], s61 offen offset:0 nt lds
  buffer_load_dwordx4 v13, s[32:35], s61 offen offset:1024 nt lds
  ds_read_b64_tr_b16 v[32:33], v20 offset:24576
  ds_read_b64_tr_b16 v[34:35], v21 offset:24576
  ds_read_b64_tr_b16 v[36:37], v22 offset:24576
  ds_read_b64_tr_b16 v[38:39], v23 offset:24576
  ds_read_b64_tr_b16 v[40:41], v24 offset:24576
  ds_read_b64_tr_b16 v[42:43], v25 offset:24576
  ds_read_b64_tr_b16 v[44:45], v26 offset:24576
  ds_read_b64_tr_b16 v[46:47], v27 offset:24576
  ds_read_b64_tr_b16 v[48:49], v20 offset:24832
  ds_read_b64_tr_b16 v[50:51], v21 offset:24832
  ds_read_b64_tr_b16 v[52:53], v22 offset:24832
  ds_read_b64_tr_b16 v[54:55], v23 offset:24832
  ds_read_b64_tr_b16 v[56:57], v24 offset:24832
  ds_read_b64_tr_b16 v[58:59], v25 offset:24832
  ds_read_b64_tr_b16 v[60:61], v26 offset:24832
  ds_read_b64_tr_b16 v[62:63], v27 offset:24832
  v_fma_f32 v120, v120, s72, -v30
  v_fma_f32 v121, v121, s72, -v30
  v_fma_f32 v122, v122, s72, -v30
  v_fma_f32 v123, v123, s72, -v30
  v_exp_f32 v120, v120
  v_exp_f32 v121, v121
  v_exp_f32 v122, v122
  v_exp_f32 v123, v123
  s_nop 0
  v_cvt_pk_bf16_f32 v156, v120, v121
  v_cvt_pk_bf16_f32 v157, v122, v123
  v_add_f32 v4, v120, v121
  v_add_f32 v5, v122, v123
  v_add_f32 v31, v31, v4
  v_add_f32 v31, v31, v5
  v_fma_f32 v124, v124, s72, -v30
  v_fma_f32 v125, v125, s72, -v30
  v_fma_f32 v126, v126, s72, -v30
  v_fma_f32 v127, v127, s72, -v30
  v_exp_f32 v124, v124
  v_exp_f32 v125, v125
  v_exp_f32 v126, v126
  v_exp_f32 v127, v127
  s_nop 0
  v_cvt_pk_bf16_f32 v158, v124, v125
  v_cvt_pk_bf16_f32 v159, v126, v127
  v_add_f32 v4, v124, v125
  v_add_f32 v5, v126, v127
  v_add_f32 v31, v31, v4
  v_add_f32 v31, v31, v5
  s_waitcnt lgkmcnt(14)
  v_mfma_f32_16x16x16_bf16 v[192:195], v[32:33], v[142:143], v[192:195]
  v_mfma_f32_16x16x16_bf16 v[196:199], v[34:35], v[142:143], v[196:199]
  s_waitcnt lgkmcnt(12)
  v_mfma_f32_16x16x16_bf16 v[200:203], v[36:37], v[142:143], v[200:203]
  v_mfma_f32_16x16x16_bf16 v[204:207], v[38:39], v[142:143], v[204:207]
  s_waitcnt lgkmcnt(10)
  v_mfma_f32_16x16x16_bf16 v[208:211], v[40:41], v[142:143], v[208:211]
  v_mfma_f32_16x16x16_bf16 v[212:215], v[42:43], v[142:143], v[212:215]
  s_waitcnt lgkmcnt(8)
  v_mfma_f32_16x16x16_bf16 v[216:219], v[44:45], v[142:143], v[216:219]
  v_mfma_f32_16x16x16_bf16 v[220:223], v[46:47], v[142:143], v[220:223]
  s_waitcnt lgkmcnt(6)
  v_mfma_f32_16x16x16_bf16 v[224:227], v[48:49], v[142:143], v[224:227]
  v_mfma_f32_16x16x16_bf16 v[228:231], v[50:51], v[142:143], v[228:231]
  s_waitcnt lgkmcnt(4)
  v_mfma_f32_16x16x16_bf16 v[232:235], v[52:53], v[142:143], v[232:235]
  v_mfma_f32_16x16x16_bf16 v[236:239], v[54:55], v[142:143], v[236:239]
  s_waitcnt lgkmcnt(2)
  v_mfma_f32_16x16x16_bf16 v[240:243], v[56:57], v[142:143], v[240:243]
  v_mfma_f32_16x16x16_bf16 v[244:247], v[58:59], v[142:143], v[244:247]
  s_waitcnt lgkmcnt(0)
  v_mfma_f32_16x16x16_bf16 v[248:251], v[60:61], v[142:143], v[248:251]
  v_mfma_f32_16x16x16_bf16 v[252:255], v[62:63], v[142:143], v[252:255]
  s_waitcnt vmcnt(8)
  buffer_load_dwordx4 v14, s[32:35], s61 offen offset:2048 nt lds
  buffer_load_dwordx4 v15, s[32:35], s61 offen offset:3072 nt lds
  s_waitcnt vmcnt(8)
  s_add_u32 m0, s64, 4096
  s_add_u32 s61, s65, 77824
  s_and_b32 s61, s61, 0x1ffff
  buffer_load_dwordx4 v12, s[32:35], s61 offen offset:0 nt lds
  buffer_load_dwordx4 v13, s[32:35], s61 offen offset:1024 nt lds
  s_waitcnt vmcnt(8)
  buffer_load_dwordx4 v14, s[32:35], s61 offen offset:2048 nt lds
  buffer_load_dwordx4 v15, s[32:35], s61 offen offset:3072 nt lds
  s_add_u32 m0, s64, 8192
  s_add_u32 s61, s65, 81920
  s_and_b32 s61, s61, 0x1ffff
  buffer_load_dwordx4 v12, s[32:35], s61 offen offset:0 nt lds
  buffer_load_dwordx4 v13, s[32:35], s61 offen offset:1024 nt lds
  buffer_load_dwordx4 v14, s[32:35], s61 offen offset:2048 nt lds
  buffer_load_dwordx4 v15, s[32:35], s61 offen offset:3072 nt lds
  s_add_u32 m0, s64, 12288
  s_add_u32 s61, s65, 86016
  s_and_b32 s61, s61, 0x1ffff
  buffer_load_dwordx4 v12, s[32:35], s61 offen offset:0 nt lds
  buffer_load_dwordx4 v13, s[32:35], s61 offen offset:1024 nt lds
  buffer_load_dwordx4 v14, s[32:35], s61 offen offset:2048 nt lds
  buffer_load_dwordx4 v15, s[32:35], s61 offen offset:3072 nt lds
  s_add_u32 m0, s64, 24576
  s_add_u32 s61, s65, 90112
  s_and_b32 s61, s61, 0x1ffff
  buffer_load_dwordx4 v12, s[32:35], s61 offen offset:0 nt lds
  buffer_load_dwordx4 v13, s[32:35], s61 offen offset:1024 nt lds
  buffer_load_dwordx4 v14, s[32:35], s61 offen offset:2048 nt lds
  buffer_load_dwordx4 v15, s[32:35], s61 offen offset:3072 nt lds
  s_add_u32 m0, s64, 28672
  s_add_u32 s61, s65, 94208
  s_and_b32 s61, s61, 0x1ffff
  buffer_load_dwordx4 v12, s[32:35], s61 offen offset:0 nt lds
  buffer_load_dwordx4 v13, s[32:35], s61 offen offset:1024 nt lds
  buffer_load_dwordx4 v14, s[32:35], s61 offen offset:2048 nt lds
  buffer_load_dwordx4 v15, s[32:35], s61 offen offset:3072 nt lds
  s_waitcnt vmcnt(24)
  ds_read_b64_tr_b16 v[32:33], v20 offset:16384
  ds_read_b64_tr_b16 v[34:35], v21 offset:16384
  ds_read_b64_tr_b16 v[36:37], v22 offset:16384
  ds_read_b64_tr_b16 v[38:39], v23 offset:16384
  ds_read_b64_tr_b16 v[40:41], v24 offset:16384
  ds_read_b64_tr_b16 v[42:43], v25 offset:16384
  ds_read_b64_tr_b16 v[44:45], v26 offset:16384
  ds_read_b64_tr_b16 v[46:47], v27 offset:16384
  ds_read_b64_tr_b16 v[48:49], v20 offset:16640
  ds_read_b64_tr_b16 v[50:51], v21 offset:16640
  ds_read_b64_tr_b16 v[52:53], v22 offset:16640
  ds_read_b64_tr_b16 v[54:55], v23 offset:16640
  ds_read_b64_tr_b16 v[56:57], v24 offset:16640
  ds_read_b64_tr_b16 v[58:59], v25 offset:16640
  ds_read_b64_tr_b16 v[60:61], v26 offset:16640
  ds_read_b64_tr_b16 v[62:63], v27 offset:16640
  s_nop 0
  s_waitcnt lgkmcnt(14)
  v_mfma_f32_16x16x16_bf16 v[192:195], v[32:33], v[144:145], v[192:195]
  v_mfma_f32_16x16x16_bf16 v[196:199], v[34:35], v[144:145], v[196:199]
  s_waitcnt lgkmcnt(12)
  v_mfma_f32_16x16x16_bf16 v[200:203], v[36:37], v[144:145], v[200:203]
  v_mfma_f32_16x16x16_bf16 v[204:207], v[38:39], v[144:145], v[204:207]
  s_waitcnt lgkmcnt(10)
  v_mfma_f32_16x16x16_bf16 v[208:211], v[40:41], v[144:145], v[208:211]
  v_mfma_f32_16x16x16_bf16 v[212:215], v[42:43], v[144:145], v[212:215]
  s_waitcnt lgkmcnt(8)
  v_mfma_f32_16x16x16_bf16 v[216:219], v[44:45], v[144:145], v[216:219]
  v_mfma_f32_16x16x16_bf16 v[220:223], v[46:47], v[144:145], v[220:223]
  s_waitcnt lgkmcnt(6)
  v_mfma_f32_16x16x16_bf16 v[224:227], v[48:49], v[144:145], v[224:227]
  v_mfma_f32_16x16x16_bf16 v[228:231], v[50:51], v[144:145], v[228:231]
  s_waitcnt lgkmcnt(4)
  v_mfma_f32_16x16x16_bf16 v[232:235], v[52:53], v[144:145], v[232:235]
  v_mfma_f32_16x16x16_bf16 v[236:239], v[54:55], v[144:145], v[236:239]
  s_waitcnt lgkmcnt(2)
  v_mfma_f32_16x16x16_bf16 v[240:243], v[56:57], v[144:145], v[240:243]
  v_mfma_f32_16x16x16_bf16 v[244:247], v[58:59], v[144:145], v[244:247]
  s_waitcnt lgkmcnt(0)
  v_mfma_f32_16x16x16_bf16 v[248:251], v[60:61], v[144:145], v[248:251]
  v_mfma_f32_16x16x16_bf16 v[252:255], v[62:63], v[144:145], v[252:255]
  s_add_u32 m0, s64, 16384
  s_add_u32 s61, s65, 98304
  s_and_b32 s61, s61, 0x1ffff
  buffer_load_dwordx4 v12, s[32:35], s61 offen offset:0 nt lds
  buffer_load_dwordx4 v13, s[32:35], s61 offen offset:1024 nt lds
  buffer_load_dwordx4 v14, s[32:35], s61 offen offset:2048 nt lds
  buffer_load_dwordx4 v15, s[32:35], s61 offen offset:3072 nt lds
  s_add_u32 m0, s64, 20480
  s_add_u32 s61, s65, 102400
  s_and_b32 s61, s61, 0x1ffff
  buffer_load_dwordx4 v12, s[32:35], s61 offen offset:0 nt lds
  buffer_load_dwordx4 v13, s[32:35], s61 offen offset:1024 nt lds
  buffer_load_dwordx4 v14, s[32:35], s61 offen offset:2048 nt lds
  buffer_load_dwordx4 v15, s[32:35], s61 offen offset:3072 nt lds
  v_and_b32 v5, 1, v2
  v_lshlrev_b32 v5, 6, v5
  v_lshl_add_u32 v5, v3, 2, v5
  s_lshl_b32 s66, s3, 4
  s_add_u32 s66, s66, 160896
  v_add_u32 v5, s66, v5
  ds_write_b32 v5, v31
  v_lshlrev_b32 v8, 10, v2
  v_lshl_add_u32 v8, v3, 4, v8
  s_lshl_b32 s66, s3, 11
  s_add_u32 s66, s66, 131072
  v_add_u32 v8, s66, v8
  v_lshrrev_b32 v9, 7, v0
  v_and_b32 v10, 127, v0
  v_lshlrev_b32 v11, 10, v9
  v_lshl_add_u32 v11, v10, 3, v11
  v_add_u32 v11, 131072, v11
  v_lshlrev_b32 v28, 4, v9
  v_add_u32 v28, 160768, v28
  v_lshlrev_b32 v29, 6, v9
  v_add_u32 v29, 160896, v29
  s_lshl_b32 s68, s4, 1
  s_add_u32 s68, s68, s26
  s_lshl_b32 s68, s68, 3
  s_add_u32 s68, s68, s27
  s_lshl_b32 s68, s68, 12
  s_add_u32 s69, s68, 1572864
  s_add_u32 s68, s68, 524288
  v_lshlrev_b32 v7, 4, v0
  v_cmp_gt_u32 s[62:63], 2, v2
  v_mov_b32 v6, 160832
  ds_read_b32 v6, v6
  s_waitcnt lgkmcnt(0)
  v_readfirstlane_b32 s75, v6
  s_waitcnt vmcnt(30)
  s_waitcnt vmcnt(28)
  s_waitcnt vmcnt(26)
  s_waitcnt vmcnt(24)
  ds_read_b64_tr_b16 v[32:33], v20 offset:0
  ds_read_b64_tr_b16 v[34:35], v21 offset:0
  ds_read_b64_tr_b16 v[36:37], v22 offset:0
  ds_read_b64_tr_b16 v[38:39], v23 offset:0
  ds_read_b64_tr_b16 v[40:41], v24 offset:0
  ds_read_b64_tr_b16 v[42:43], v25 offset:0
  ds_read_b64_tr_b16 v[44:45], v26 offset:0
  ds_read_b64_tr_b16 v[46:47], v27 offset:0
  ds_read_b64_tr_b16 v[48:49], v20 offset:256
  ds_read_b64_tr_b16 v[50:51], v21 offset:256
  ds_read_b64_tr_b16 v[52:53], v22 offset:256
  ds_read_b64_tr_b16 v[54:55], v23 offset:256
  ds_read_b64_tr_b16 v[56:57], v24 offset:256
  ds_read_b64_tr_b16 v[58:59], v25 offset:256
  ds_read_b64_tr_b16 v[60:61], v26 offset:256
  ds_read_b64_tr_b16 v[62:63], v27 offset:256
  s_nop 0
  s_waitcnt lgkmcnt(14)
  v_mfma_f32_16x16x16_bf16 v[192:195], v[32:33], v[146:147], v[192:195]
  v_mfma_f32_16x16x16_bf16 v[196:199], v[34:35], v[146:147], v[196:199]
  s_waitcnt lgkmcnt(12)
  v_mfma_f32_16x16x16_bf16 v[200:203], v[36:37], v[146:147], v[200:203]
  v_mfma_f32_16x16x16_bf16 v[204:207], v[38:39], v[146:147], v[204:207]
  s_waitcnt lgkmcnt(10)
  v_mfma_f32_16x16x16_bf16 v[208:211], v[40:41], v[146:147], v[208:211]
  v_mfma_f32_16x16x16_bf16 v[212:215], v[42:43], v[146:147], v[212:215]
  s_waitcnt lgkmcnt(8)
  v_mfma_f32_16x16x16_bf16 v[216:219], v[44:45], v[146:147], v[216:219]
  v_mfma_f32_16x16x16_bf16 v[220:223], v[46:47], v[146:147], v[220:223]
  s_waitcnt lgkmcnt(6)
  v_mfma_f32_16x16x16_bf16 v[224:227], v[48:49], v[146:147], v[224:227]
  v_mfma_f32_16x16x16_bf16 v[228:231], v[50:51], v[146:147], v[228:231]
  s_waitcnt lgkmcnt(4)
  v_mfma_f32_16x16x16_bf16 v[232:235], v[52:53], v[146:147], v[232:235]
  v_mfma_f32_16x16x16_bf16 v[236:239], v[54:55], v[146:147], v[236:239]
  s_waitcnt lgkmcnt(2)
  v_mfma_f32_16x16x16_bf16 v[240:243], v[56:57], v[146:147], v[240:243]
  v_mfma_f32_16x16x16_bf16 v[244:247], v[58:59], v[146:147], v[244:247]
  s_waitcnt lgkmcnt(0)
  v_mfma_f32_16x16x16_bf16 v[248:251], v[60:61], v[146:147], v[248:251]
  v_mfma_f32_16x16x16_bf16 v[252:255], v[62:63], v[146:147], v[252:255]
  s_add_u32 m0, s64, 0
  s_add_u32 s61, s65, 106496
  s_and_b32 s61, s61, 0x1ffff
  buffer_load_dwordx4 v12, s[32:35], s61 offen offset:0 nt lds
  buffer_load_dwordx4 v13, s[32:35], s61 offen offset:1024 nt lds
  buffer_load_dwordx4 v14, s[32:35], s61 offen offset:2048 nt lds
  buffer_load_dwordx4 v15, s[32:35], s61 offen offset:3072 nt lds
  s_add_u32 m0, s64, 4096
  s_add_u32 s61, s65, 110592
  s_and_b32 s61, s61, 0x1ffff
  buffer_load_dwordx4 v12, s[32:35], s61 offen offset:0 nt lds
  buffer_load_dwordx4 v13, s[32:35], s61 offen offset:1024 nt lds
  buffer_load_dwordx4 v14, s[32:35], s61 offen offset:2048 nt lds
  buffer_load_dwordx4 v15, s[32:35], s61 offen offset:3072 nt lds
  s_waitcnt vmcnt(30)
  s_waitcnt vmcnt(28)
  s_waitcnt vmcnt(26)
  s_waitcnt vmcnt(24)
  ds_read_b64_tr_b16 v[32:33], v20 offset:8192
  ds_read_b64_tr_b16 v[34:35], v21 offset:8192
  ds_read_b64_tr_b16 v[36:37], v22 offset:8192
  ds_read_b64_tr_b16 v[38:39], v23 offset:8192
  ds_read_b64_tr_b16 v[40:41], v24 offset:8192
  ds_read_b64_tr_b16 v[42:43], v25 offset:8192
  ds_read_b64_tr_b16 v[44:45], v26 offset:8192
  ds_read_b64_tr_b16 v[46:47], v27 offset:8192
  ds_read_b64_tr_b16 v[48:49], v20 offset:8448
  ds_read_b64_tr_b16 v[50:51], v21 offset:8448
  ds_read_b64_tr_b16 v[52:53], v22 offset:8448
  ds_read_b64_tr_b16 v[54:55], v23 offset:8448
  ds_read_b64_tr_b16 v[56:57], v24 offset:8448
  ds_read_b64_tr_b16 v[58:59], v25 offset:8448
  ds_read_b64_tr_b16 v[60:61], v26 offset:8448
  ds_read_b64_tr_b16 v[62:63], v27 offset:8448
  s_nop 0
  s_waitcnt lgkmcnt(14)
  v_mfma_f32_16x16x16_bf16 v[192:195], v[32:33], v[148:149], v[192:195]
  v_mfma_f32_16x16x16_bf16 v[196:199], v[34:35], v[148:149], v[196:199]
  s_waitcnt lgkmcnt(12)
  v_mfma_f32_16x16x16_bf16 v[200:203], v[36:37], v[148:149], v[200:203]
  v_mfma_f32_16x16x16_bf16 v[204:207], v[38:39], v[148:149], v[204:207]
  s_waitcnt lgkmcnt(10)
  v_mfma_f32_16x16x16_bf16 v[208:211], v[40:41], v[148:149], v[208:211]
  v_mfma_f32_16x16x16_bf16 v[212:215], v[42:43], v[148:149], v[212:215]
  s_waitcnt lgkmcnt(8)
  v_mfma_f32_16x16x16_bf16 v[216:219], v[44:45], v[148:149], v[216:219]
  v_mfma_f32_16x16x16_bf16 v[220:223], v[46:47], v[148:149], v[220:223]
  s_waitcnt lgkmcnt(6)
  v_mfma_f32_16x16x16_bf16 v[224:227], v[48:49], v[148:149], v[224:227]
  v_mfma_f32_16x16x16_bf16 v[228:231], v[50:51], v[148:149], v[228:231]
  s_waitcnt lgkmcnt(4)
  v_mfma_f32_16x16x16_bf16 v[232:235], v[52:53], v[148:149], v[232:235]
  v_mfma_f32_16x16x16_bf16 v[236:239], v[54:55], v[148:149], v[236:239]
  s_waitcnt lgkmcnt(2)
  v_mfma_f32_16x16x16_bf16 v[240:243], v[56:57], v[148:149], v[240:243]
  v_mfma_f32_16x16x16_bf16 v[244:247], v[58:59], v[148:149], v[244:247]
  s_waitcnt lgkmcnt(0)
  v_mfma_f32_16x16x16_bf16 v[248:251], v[60:61], v[148:149], v[248:251]
  v_mfma_f32_16x16x16_bf16 v[252:255], v[62:63], v[148:149], v[252:255]
  s_add_u32 m0, s64, 8192
  s_add_u32 s61, s65, 114688
  s_and_b32 s61, s61, 0x1ffff
  buffer_load_dwordx4 v12, s[32:35], s61 offen offset:0 nt lds
  buffer_load_dwordx4 v13, s[32:35], s61 offen offset:1024 nt lds
  buffer_load_dwordx4 v14, s[32:35], s61 offen offset:2048 nt lds
  buffer_load_dwordx4 v15, s[32:35], s61 offen offset:3072 nt lds
  s_add_u32 m0, s64, 12288
  s_add_u32 s61, s65, 118784
  s_and_b32 s61, s61, 0x1ffff
  buffer_load_dwordx4 v12, s[32:35], s61 offen offset:0 nt lds
  buffer_load_dwordx4 v13, s[32:35], s61 offen offset:1024 nt lds
  buffer_load_dwordx4 v14, s[32:35], s61 offen offset:2048 nt lds
  buffer_load_dwordx4 v15, s[32:35], s61 offen offset:3072 nt lds
  s_waitcnt vmcnt(30)
  s_waitcnt vmcnt(28)
  s_waitcnt vmcnt(26)
  s_waitcnt vmcnt(24)
  ds_read_b64_tr_b16 v[32:33], v20 offset:24576
  ds_read_b64_tr_b16 v[34:35], v21 offset:24576
  ds_read_b64_tr_b16 v[36:37], v22 offset:24576
  ds_read_b64_tr_b16 v[38:39], v23 offset:24576
  ds_read_b64_tr_b16 v[40:41], v24 offset:24576
  ds_read_b64_tr_b16 v[42:43], v25 offset:24576
  ds_read_b64_tr_b16 v[44:45], v26 offset:24576
  ds_read_b64_tr_b16 v[46:47], v27 offset:24576
  ds_read_b64_tr_b16 v[48:49], v20 offset:24832
  ds_read_b64_tr_b16 v[50:51], v21 offset:24832
  ds_read_b64_tr_b16 v[52:53], v22 offset:24832
  ds_read_b64_tr_b16 v[54:55], v23 offset:24832
  ds_read_b64_tr_b16 v[56:57], v24 offset:24832
  ds_read_b64_tr_b16 v[58:59], v25 offset:24832
  ds_read_b64_tr_b16 v[60:61], v26 offset:24832
  ds_read_b64_tr_b16 v[62:63], v27 offset:24832
  s_nop 0
  s_waitcnt lgkmcnt(14)
  v_mfma_f32_16x16x16_bf16 v[192:195], v[32:33], v[150:151], v[192:195]
  v_mfma_f32_16x16x16_bf16 v[196:199], v[34:35], v[150:151], v[196:199]
  s_waitcnt lgkmcnt(12)
  v_mfma_f32_16x16x16_bf16 v[200:203], v[36:37], v[150:151], v[200:203]
  v_mfma_f32_16x16x16_bf16 v[204:207], v[38:39], v[150:151], v[204:207]
  s_waitcnt lgkmcnt(10)
  v_mfma_f32_16x16x16_bf16 v[208:211], v[40:41], v[150:151], v[208:211]
  v_mfma_f32_16x16x16_bf16 v[212:215], v[42:43], v[150:151], v[212:215]
  s_waitcnt lgkmcnt(8)
  v_mfma_f32_16x16x16_bf16 v[216:219], v[44:45], v[150:151], v[216:219]
  v_mfma_f32_16x16x16_bf16 v[220:223], v[46:47], v[150:151], v[220:223]
  s_waitcnt lgkmcnt(6)
  v_mfma_f32_16x16x16_bf16 v[224:227], v[48:49], v[150:151], v[224:227]
  v_mfma_f32_16x16x16_bf16 v[228:231], v[50:51], v[150:151], v[228:231]
  s_waitcnt lgkmcnt(4)
  v_mfma_f32_16x16x16_bf16 v[232:235], v[52:53], v[150:151], v[232:235]
  v_mfma_f32_16x16x16_bf16 v[236:239], v[54:55], v[150:151], v[236:239]
  s_waitcnt lgkmcnt(2)
  v_mfma_f32_16x16x16_bf16 v[240:243], v[56:57], v[150:151], v[240:243]
  v_mfma_f32_16x16x16_bf16 v[244:247], v[58:59], v[150:151], v[244:247]
  s_waitcnt lgkmcnt(0)
  v_mfma_f32_16x16x16_bf16 v[248:251], v[60:61], v[150:151], v[248:251]
  v_mfma_f32_16x16x16_bf16 v[252:255], v[62:63], v[150:151], v[252:255]
  s_add_u32 m0, s64, 24576
  s_add_u32 s61, s65, 122880
  s_and_b32 s61, s61, 0x1ffff
  buffer_load_dwordx4 v12, s[32:35], s61 offen offset:0 nt lds
  buffer_load_dwordx4 v13, s[32:35], s61 offen offset:1024 nt lds
  buffer_load_dwordx4 v14, s[32:35], s61 offen offset:2048 nt lds
  buffer_load_dwordx4 v15, s[32:35], s61 offen offset:3072 nt lds
  s_add_u32 m0, s64, 28672
  s_add_u32 s61, s65, 126976
  s_and_b32 s61, s61, 0x1ffff
  buffer_load_dwordx4 v12, s[32:35], s61 offen offset:0 nt lds
  buffer_load_dwordx4 v13, s[32:35], s61 offen offset:1024 nt lds
  buffer_load_dwordx4 v14, s[32:35], s61 offen offset:2048 nt lds
  buffer_load_dwordx4 v15, s[32:35], s61 offen offset:3072 nt lds
  s_waitcnt vmcnt(30)
  s_waitcnt vmcnt(28)
  s_waitcnt vmcnt(26)
  s_waitcnt vmcnt(24)
  ds_read_b64_tr_b16 v[32:33], v20 offset:16384
  ds_read_b64_tr_b16 v[34:35], v21 offset:16384
  ds_read_b64_tr_b16 v[36:37], v22 offset:16384
  ds_read_b64_tr_b16 v[38:39], v23 offset:16384
  ds_read_b64_tr_b16 v[40:41], v24 offset:16384
  ds_read_b64_tr_b16 v[42:43], v25 offset:16384
  ds_read_b64_tr_b16 v[44:45], v26 offset:16384
  ds_read_b64_tr_b16 v[46:47], v27 offset:16384
  ds_read_b64_tr_b16 v[48:49], v20 offset:16640
  ds_read_b64_tr_b16 v[50:51], v21 offset:16640
  ds_read_b64_tr_b16 v[52:53], v22 offset:16640
  ds_read_b64_tr_b16 v[54:55], v23 offset:16640
  ds_read_b64_tr_b16 v[56:57], v24 offset:16640
  ds_read_b64_tr_b16 v[58:59], v25 offset:16640
  ds_read_b64_tr_b16 v[60:61], v26 offset:16640
  ds_read_b64_tr_b16 v[62:63], v27 offset:16640
  s_nop 0
  s_waitcnt lgkmcnt(14)
  v_mfma_f32_16x16x16_bf16 v[192:195], v[32:33], v[152:153], v[192:195]
  v_mfma_f32_16x16x16_bf16 v[196:199], v[34:35], v[152:153], v[196:199]
  s_waitcnt lgkmcnt(12)
  v_mfma_f32_16x16x16_bf16 v[200:203], v[36:37], v[152:153], v[200:203]
  v_mfma_f32_16x16x16_bf16 v[204:207], v[38:39], v[152:153], v[204:207]
  s_waitcnt lgkmcnt(10)
  v_mfma_f32_16x16x16_bf16 v[208:211], v[40:41], v[152:153], v[208:211]
  v_mfma_f32_16x16x16_bf16 v[212:215], v[42:43], v[152:153], v[212:215]
  s_waitcnt lgkmcnt(8)
  v_mfma_f32_16x16x16_bf16 v[216:219], v[44:45], v[152:153], v[216:219]
  v_mfma_f32_16x16x16_bf16 v[220:223], v[46:47], v[152:153], v[220:223]
  s_waitcnt lgkmcnt(6)
  v_mfma_f32_16x16x16_bf16 v[224:227], v[48:49], v[152:153], v[224:227]
  v_mfma_f32_16x16x16_bf16 v[228:231], v[50:51], v[152:153], v[228:231]
  s_waitcnt lgkmcnt(4)
  v_mfma_f32_16x16x16_bf16 v[232:235], v[52:53], v[152:153], v[232:235]
  v_mfma_f32_16x16x16_bf16 v[236:239], v[54:55], v[152:153], v[236:239]
  s_waitcnt lgkmcnt(2)
  v_mfma_f32_16x16x16_bf16 v[240:243], v[56:57], v[152:153], v[240:243]
  v_mfma_f32_16x16x16_bf16 v[244:247], v[58:59], v[152:153], v[244:247]
  s_waitcnt lgkmcnt(0)
  v_mfma_f32_16x16x16_bf16 v[248:251], v[60:61], v[152:153], v[248:251]
  v_mfma_f32_16x16x16_bf16 v[252:255], v[62:63], v[152:153], v[252:255]
  s_waitcnt vmcnt(22)
  s_waitcnt vmcnt(20)
  s_waitcnt vmcnt(18)
  s_waitcnt vmcnt(16)
  ds_read_b64_tr_b16 v[32:33], v20 offset:0
  ds_read_b64_tr_b16 v[34:35], v21 offset:0
  ds_read_b64_tr_b16 v[36:37], v22 offset:0
  ds_read_b64_tr_b16 v[38:39], v23 offset:0
  ds_read_b64_tr_b16 v[40:41], v24 offset:0
  ds_read_b64_tr_b16 v[42:43], v25 offset:0
  ds_read_b64_tr_b16 v[44:45], v26 offset:0
  ds_read_b64_tr_b16 v[46:47], v27 offset:0
  ds_read_b64_tr_b16 v[48:49], v20 offset:256
  ds_read_b64_tr_b16 v[50:51], v21 offset:256
  ds_read_b64_tr_b16 v[52:53], v22 offset:256
  ds_read_b64_tr_b16 v[54:55], v23 offset:256
  ds_read_b64_tr_b16 v[56:57], v24 offset:256
  ds_read_b64_tr_b16 v[58:59], v25 offset:256
  ds_read_b64_tr_b16 v[60:61], v26 offset:256
  ds_read_b64_tr_b16 v[62:63], v27 offset:256
  s_nop 0
  s_waitcnt lgkmcnt(14)
  v_mfma_f32_16x16x16_bf16 v[192:195], v[32:33], v[154:155], v[192:195]
  v_mfma_f32_16x16x16_bf16 v[196:199], v[34:35], v[154:155], v[196:199]
  s_waitcnt lgkmcnt(12)
  v_mfma_f32_16x16x16_bf16 v[200:203], v[36:37], v[154:155], v[200:203]
  v_mfma_f32_16x16x16_bf16 v[204:207], v[38:39], v[154:155], v[204:207]
  s_waitcnt lgkmcnt(10)
  v_mfma_f32_16x16x16_bf16 v[208:211], v[40:41], v[154:155], v[208:211]
  v_mfma_f32_16x16x16_bf16 v[212:215], v[42:43], v[154:155], v[212:215]
  s_waitcnt lgkmcnt(8)
  v_mfma_f32_16x16x16_bf16 v[216:219], v[44:45], v[154:155], v[216:219]
  v_mfma_f32_16x16x16_bf16 v[220:223], v[46:47], v[154:155], v[220:223]
  s_waitcnt lgkmcnt(6)
  v_mfma_f32_16x16x16_bf16 v[224:227], v[48:49], v[154:155], v[224:227]
  v_mfma_f32_16x16x16_bf16 v[228:231], v[50:51], v[154:155], v[228:231]
  s_waitcnt lgkmcnt(4)
  v_mfma_f32_16x16x16_bf16 v[232:235], v[52:53], v[154:155], v[232:235]
  v_mfma_f32_16x16x16_bf16 v[236:239], v[54:55], v[154:155], v[236:239]
  s_waitcnt lgkmcnt(2)
  v_mfma_f32_16x16x16_bf16 v[240:243], v[56:57], v[154:155], v[240:243]
  v_mfma_f32_16x16x16_bf16 v[244:247], v[58:59], v[154:155], v[244:247]
  s_waitcnt lgkmcnt(0)
  v_mfma_f32_16x16x16_bf16 v[248:251], v[60:61], v[154:155], v[248:251]
  v_mfma_f32_16x16x16_bf16 v[252:255], v[62:63], v[154:155], v[252:255]
  s_waitcnt vmcnt(14)
  s_waitcnt vmcnt(12)
  s_waitcnt vmcnt(10)
  s_waitcnt vmcnt(8)
  ds_read_b64_tr_b16 v[32:33], v20 offset:8192
  ds_read_b64_tr_b16 v[34:35], v21 offset:8192
  ds_read_b64_tr_b16 v[36:37], v22 offset:8192
  ds_read_b64_tr_b16 v[38:39], v23 offset:8192
  ds_read_b64_tr_b16 v[40:41], v24 offset:8192
  ds_read_b64_tr_b16 v[42:43], v25 offset:8192
  ds_read_b64_tr_b16 v[44:45], v26 offset:8192
  ds_read_b64_tr_b16 v[46:47], v27 offset:8192
  ds_read_b64_tr_b16 v[48:49], v20 offset:8448
  ds_read_b64_tr_b16 v[50:51], v21 offset:8448
  ds_read_b64_tr_b16 v[52:53], v22 offset:8448
  ds_read_b64_tr_b16 v[54:55], v23 offset:8448
  ds_read_b64_tr_b16 v[56:57], v24 offset:8448
  ds_read_b64_tr_b16 v[58:59], v25 offset:8448
  ds_read_b64_tr_b16 v[60:61], v26 offset:8448
  ds_read_b64_tr_b16 v[62:63], v27 offset:8448
  s_nop 0
  s_waitcnt lgkmcnt(14)
  v_mfma_f32_16x16x16_bf16 v[192:195], v[32:33], v[156:157], v[192:195]
  v_mfma_f32_16x16x16_bf16 v[196:199], v[34:35], v[156:157], v[196:199]
  s_waitcnt lgkmcnt(12)
  v_mfma_f32_16x16x16_bf16 v[200:203], v[36:37], v[156:157], v[200:203]
  v_mfma_f32_16x16x16_bf16 v[204:207], v[38:39], v[156:157], v[204:207]
  s_waitcnt lgkmcnt(10)
  v_mfma_f32_16x16x16_bf16 v[208:211], v[40:41], v[156:157], v[208:211]
  v_mfma_f32_16x16x16_bf16 v[212:215], v[42:43], v[156:157], v[212:215]
  s_waitcnt lgkmcnt(8)
  v_mfma_f32_16x16x16_bf16 v[216:219], v[44:45], v[156:157], v[216:219]
  v_mfma_f32_16x16x16_bf16 v[220:223], v[46:47], v[156:157], v[220:223]
  s_waitcnt lgkmcnt(6)
  v_mfma_f32_16x16x16_bf16 v[224:227], v[48:49], v[156:157], v[224:227]
  v_mfma_f32_16x16x16_bf16 v[228:231], v[50:51], v[156:157], v[228:231]
  s_waitcnt lgkmcnt(4)
  v_mfma_f32_16x16x16_bf16 v[232:235], v[52:53], v[156:157], v[232:235]
  v_mfma_f32_16x16x16_bf16 v[236:239], v[54:55], v[156:157], v[236:239]
  s_waitcnt lgkmcnt(2)
  v_mfma_f32_16x16x16_bf16 v[240:243], v[56:57], v[156:157], v[240:243]
  v_mfma_f32_16x16x16_bf16 v[244:247], v[58:59], v[156:157], v[244:247]
  s_waitcnt lgkmcnt(0)
  v_mfma_f32_16x16x16_bf16 v[248:251], v[60:61], v[156:157], v[248:251]
  v_mfma_f32_16x16x16_bf16 v[252:255], v[62:63], v[156:157], v[252:255]
  s_waitcnt vmcnt(6)
  s_waitcnt vmcnt(4)
  s_waitcnt vmcnt(2)
  s_waitcnt vmcnt(0)
  ds_read_b64_tr_b16 v[32:33], v20 offset:24576
  ds_read_b64_tr_b16 v[34:35], v21 offset:24576
  ds_read_b64_tr_b16 v[36:37], v22 offset:24576
  ds_read_b64_tr_b16 v[38:39], v23 offset:24576
  ds_read_b64_tr_b16 v[40:41], v24 offset:24576
  ds_read_b64_tr_b16 v[42:43], v25 offset:24576
  ds_read_b64_tr_b16 v[44:45], v26 offset:24576
  ds_read_b64_tr_b16 v[46:47], v27 offset:24576
  ds_read_b64_tr_b16 v[48:49], v20 offset:24832
  ds_read_b64_tr_b16 v[50:51], v21 offset:24832
  ds_read_b64_tr_b16 v[52:53], v22 offset:24832
  ds_read_b64_tr_b16 v[54:55], v23 offset:24832
  ds_read_b64_tr_b16 v[56:57], v24 offset:24832
  ds_read_b64_tr_b16 v[58:59], v25 offset:24832
  ds_read_b64_tr_b16 v[60:61], v26 offset:24832
  ds_read_b64_tr_b16 v[62:63], v27 offset:24832
  s_nop 0
  s_waitcnt lgkmcnt(14)
  v_mfma_f32_16x16x16_bf16 v[192:195], v[32:33], v[158:159], v[192:195]
  v_mfma_f32_16x16x16_bf16 v[196:199], v[34:35], v[158:159], v[196:199]
  s_waitcnt lgkmcnt(12)
  v_mfma_f32_16x16x16_bf16 v[200:203], v[36:37], v[158:159], v[200:203]
  v_mfma_f32_16x16x16_bf16 v[204:207], v[38:39], v[158:159], v[204:207]
  s_waitcnt lgkmcnt(10)
  v_mfma_f32_16x16x16_bf16 v[208:211], v[40:41], v[158:159], v[208:211]
  v_mfma_f32_16x16x16_bf16 v[212:215], v[42:43], v[158:159], v[212:215]
  s_waitcnt lgkmcnt(8)
  v_mfma_f32_16x16x16_bf16 v[216:219], v[44:45], v[158:159], v[216:219]
  v_mfma_f32_16x16x16_bf16 v[220:223], v[46:47], v[158:159], v[220:223]
  s_waitcnt lgkmcnt(6)
  v_mfma_f32_16x16x16_bf16 v[224:227], v[48:49], v[158:159], v[224:227]
  v_mfma_f32_16x16x16_bf16 v[228:231], v[50:51], v[158:159], v[228:231]
  s_waitcnt lgkmcnt(4)
  v_mfma_f32_16x16x16_bf16 v[232:235], v[52:53], v[158:159], v[232:235]
  v_mfma_f32_16x16x16_bf16 v[236:239], v[54:55], v[158:159], v[236:239]
  s_waitcnt lgkmcnt(2)
  v_mfma_f32_16x16x16_bf16 v[240:243], v[56:57], v[158:159], v[240:243]
  v_mfma_f32_16x16x16_bf16 v[244:247], v[58:59], v[158:159], v[244:247]
  s_waitcnt lgkmcnt(0)
  v_mfma_f32_16x16x16_bf16 v[248:251], v[60:61], v[158:159], v[248:251]
  v_mfma_f32_16x16x16_bf16 v[252:255], v[62:63], v[158:159], v[252:255]
  s_mov_b64 s[66:67], exec
  s_mov_b64 exec, s[62:63]
  s_nop 5
  ds_write_b128 v8, v[192:195] offset:0
  ds_write_b128 v8, v[196:199] offset:64
  ds_write_b128 v8, v[200:203] offset:128
  ds_write_b128 v8, v[204:207] offset:192
  ds_write_b128 v8, v[208:211] offset:256
  ds_write_b128 v8, v[212:215] offset:320
  ds_write_b128 v8, v[216:219] offset:384
  ds_write_b128 v8, v[220:223] offset:448
  ds_write_b128 v8, v[224:227] offset:512
  ds_write_b128 v8, v[228:231] offset:576
  ds_write_b128 v8, v[232:235] offset:640
  ds_write_b128 v8, v[236:239] offset:704
  ds_write_b128 v8, v[240:243] offset:768
  ds_write_b128 v8, v[244:247] offset:832
  ds_write_b128 v8, v[248:251] offset:896
  ds_write_b128 v8, v[252:255] offset:960
  s_mov_b64 exec, s[66:67]
  s_waitcnt lgkmcnt(0)
  s_barrier
  ds_read_b64 v[32:33], v11 offset:0
  ds_read_b64 v[34:35], v11 offset:2048
  ds_read_b64 v[36:37], v11 offset:4096
  ds_read_b64 v[38:39], v11 offset:6144
  ds_read_b128 v[40:43], v28
  ds_read_b128 v[44:47], v29 offset:0
  ds_read_b128 v[48:51], v29 offset:16
  ds_read_b128 v[52:55], v29 offset:32
  ds_read_b128 v[56:59], v29 offset:48
  v_mov_b32 v16, 0xfffffffe
  s_waitcnt lgkmcnt(4)
  v_max3_f32 v14, v40, v41, v42
  v_max_f32 v14, v14, v43
  v_sub_f32 v40, v40, v14
  v_sub_f32 v41, v41, v14
  v_sub_f32 v42, v42, v14
  v_sub_f32 v43, v43, v14
  v_exp_f32 v40, v40
  v_exp_f32 v41, v41
  v_exp_f32 v42, v42
  v_exp_f32 v43, v43
  s_waitcnt lgkmcnt(0)
  v_mul_f32 v12, v40, v32
  v_mul_f32 v13, v40, v33
  v_fmac_f32 v12, v41, v34
  v_fmac_f32 v13, v41, v35
  v_fmac_f32 v12, v42, v36
  v_fmac_f32 v13, v42, v37
  v_fmac_f32 v12, v43, v38
  v_fmac_f32 v13, v43, v39
  v_add_f32 v44, v44, v45
  v_add_f32 v46, v46, v47
  v_add_f32 v44, v44, v46
  v_add_f32 v48, v48, v49
  v_add_f32 v50, v50, v51
  v_add_f32 v48, v48, v50
  v_add_f32 v52, v52, v53
  v_add_f32 v54, v54, v55
  v_add_f32 v52, v52, v54
  v_add_f32 v56, v56, v57
  v_add_f32 v58, v58, v59
  v_add_f32 v56, v56, v58
  v_mul_f32 v15, v40, v44
  v_fmac_f32 v15, v41, v48
  v_fmac_f32 v15, v42, v52
  v_fmac_f32 v15, v43, v56
  v_min_u32 v12, v12, v16
  v_min_u32 v13, v13, v16
  v_min_u32 v14, v14, v16
  v_min_u32 v15, v15, v16
  buffer_store_dwordx4 v[12:15], v7, s[44:47], s69 offen
  s_mov_b32 s61, s68
  s_mov_b32 s60, 0
  s_cmp_ge_u32 s5, 14
  s_cbranch_scc0 L_h1
  buffer_store_dwordx4 v[12:15], v7, s[44:47], s68 offen sc1
  s_branch L_final
L_h1:
  v_lshlrev_b32 v4, 15, v9
  v_lshl_add_u32 v4, v10, 4, v4
  s_lshl_b32 s66, s73, 11
  s_lshl_b32 s67, s4, 16
  s_add_u32 s66, s66, s67
  s_add_u32 s68, s66, 1572864
  s_add_u32 s69, s66, 524288
  s_lshr_b32 s67, s3, 1
  s_lshl_b32 s67, s67, 3
  s_lshr_b32 s75, s75, s67
  s_mov_b32 s70, 0xff
  s_mov_b32 s71, 0
L_h1poll:
  s_bitcmp1_b32 s70, 0
  s_cbranch_scc0 L_h1skip0
  s_bitcmp1_b32 s75, 0
  s_cselect_b32 s67, s68, s69
  buffer_load_dwordx4 v[64:67], v4, s[44:47], s67 offen sc1
L_h1skip0:
  s_bitcmp1_b32 s70, 1
  s_cbranch_scc0 L_h1skip1
  s_bitcmp1_b32 s75, 1
  s_cselect_b32 s67, s68, s69
  s_add_u32 s67, s67, 4096
  buffer_load_dwordx4 v[68:71], v4, s[44:47], s67 offen sc1
L_h1skip1:
  s_bitcmp1_b32 s70, 2
  s_cbranch_scc0 L_h1skip2
  s_bitcmp1_b32 s75, 2
  s_cselect_b32 s67, s68, s69
  s_add_u32 s67, s67, 8192
  buffer_load_dwordx4 v[72:75], v4, s[44:47], s67 offen sc1
L_h1skip2:
  s_bitcmp1_b32 s70, 3
  s_cbranch_scc0 L_h1skip3
  s_bitcmp1_b32 s75, 3
  s_cselect_b32 s67, s68, s69
  s_add_u32 s67, s67, 12288
  buffer_load_dwordx4 v[76:79], v4, s[44:47], s67 offen sc1
L_h1skip3:
  s_bitcmp1_b32 s70, 4
  s_cbranch_scc0 L_h1skip4
  s_bitcmp1_b32 s75, 4
  s_cselect_b32 s67, s68, s69
  s_add_u32 s67, s67, 16384
  buffer_load_dwordx4 v[80:83], v4, s[44:47], s67 offen sc1
L_h1skip4:
  s_bitcmp1_b32 s70, 5
  s_cbranch_scc0 L_h1skip5
  s_bitcmp1_b32 s75, 5
  s_cselect_b32 s67, s68, s69
  s_add_u32 s67, s67, 20480
  buffer_load_dwordx4 v[84:87], v4, s[44:47], s67 offen sc1
L_h1skip5:
  s_bitcmp1_b32 s70, 6
  s_cbranch_scc0 L_h1skip6
  s_bitcmp1_b32 s75, 6
  s_cselect_b32 s67, s68, s69
  s_add_u32 s67, s67, 24576
  buffer_load_dwordx4 v[88:91], v4, s[44:47], s67 offen sc1
L_h1skip6:
  s_bitcmp1_b32 s70, 7
  s_cbranch_scc0 L_h1skip7
  s_bitcmp1_b32 s75, 7
  s_cselect_b32 s67, s68, s69
  s_add_u32 s67, s67, 28672
  buffer_load_dwordx4 v[92:95], v4, s[44:47], s67 offen sc1
L_h1skip7:
  s_cmp_lg_u32 s60, 0
  s_cbranch_scc1 L_h1w0
  s_mov_b32 s60, 1
  buffer_store_dwordx4 v[12:15], v7, s[44:47], s61 offen sc1
  s_waitcnt vmcnt(1)
  s_branch L_h1w1
L_h1w0:
  s_waitcnt vmcnt(0)
L_h1w1:
  s_bitcmp1_b32 s70, 0
  s_cbranch_scc0 L_h1chk0
  v_max3_u32 v7, v64, v65, v66
  v_max_u32 v7, v7, v67
  v_cmp_eq_u32 vcc, -1, v7
  s_cmp_eq_u64 vcc, 0
  s_cbranch_scc0 L_h1chk0
  s_bitset0_b32 s70, 0
L_h1chk0:
  s_bitcmp1_b32 s70, 1
  s_cbranch_scc0 L_h1chk1
  v_max3_u32 v7, v68, v69, v70
  v_max_u32 v7, v7, v71
  v_cmp_eq_u32 vcc, -1, v7
  s_cmp_eq_u64 vcc, 0
  s_cbranch_scc0 L_h1chk1
  s_bitset0_b32 s70, 1
L_h1chk1:
  s_bitcmp1_b32 s70, 2
  s_cbranch_scc0 L_h1chk2
  v_max3_u32 v7, v72, v73, v74
  v_max_u32 v7, v7, v75
  v_cmp_eq_u32 vcc, -1, v7
  s_cmp_eq_u64 vcc, 0
  s_cbranch_scc0 L_h1chk2
  s_bitset0_b32 s70, 2
L_h1chk2:
  s_bitcmp1_b32 s70, 3
  s_cbranch_scc0 L_h1chk3
  v_max3_u32 v7, v76, v77, v78
  v_max_u32 v7, v7, v79
  v_cmp_eq_u32 vcc, -1, v7
  s_cmp_eq_u64 vcc, 0
  s_cbranch_scc0 L_h1chk3
  s_bitset0_b32 s70, 3
L_h1chk3:
  s_bitcmp1_b32 s70, 4
  s_cbranch_scc0 L_h1chk4
  v_max3_u32 v7, v80, v81, v82
  v_max_u32 v7, v7, v83
  v_cmp_eq_u32 vcc, -1, v7
  s_cmp_eq_u64 vcc, 0
  s_cbranch_scc0 L_h1chk4
  s_bitset0_b32 s70, 4
L_h1chk4:
  s_bitcmp1_b32 s70, 5
  s_cbranch_scc0 L_h1chk5
  v_max3_u32 v7, v84, v85, v86
  v_max_u32 v7, v7, v87
  v_cmp_eq_u32 vcc, -1, v7
  s_cmp_eq_u64 vcc, 0
  s_cbranch_scc0 L_h1chk5
  s_bitset0_b32 s70, 5
L_h1chk5:
  s_bitcmp1_b32 s70, 6
  s_cbranch_scc0 L_h1chk6
  v_max3_u32 v7, v88, v89, v90
  v_max_u32 v7, v7, v91
  v_cmp_eq_u32 vcc, -1, v7
  s_cmp_eq_u64 vcc, 0
  s_cbranch_scc0 L_h1chk6
  s_bitset0_b32 s70, 6
L_h1chk6:
  s_bitcmp1_b32 s70, 7
  s_cbranch_scc0 L_h1chk7
  v_max3_u32 v7, v92, v93, v94
  v_max_u32 v7, v7, v95
  v_cmp_eq_u32 vcc, -1, v7
  s_cmp_eq_u64 vcc, 0
  s_cbranch_scc0 L_h1chk7
  s_bitset0_b32 s70, 7
L_h1chk7:
  s_cmp_eq_u32 s70, 0
  s_cbranch_scc1 L_h1done
  s_add_u32 s71, s71, 1
  s_cmp_lt_u32 s71, 64
  s_cselect_b32 s75, s75, 0
  s_cmp_lt_u32 s71, 40000
  s_cbranch_scc1 L_h1poll
L_h1done:
  v_max3_f32 v7, v66, v70, v74
  v_max3_f32 v7, v7, v78, v82
  v_max3_f32 v7, v7, v86, v90
  v_max_f32 v7, v7, v94
  v_sub_f32 v66, v66, v7
  v_sub_f32 v70, v70, v7
  v_sub_f32 v74, v74, v7
  v_sub_f32 v78, v78, v7
  v_sub_f32 v82, v82, v7
  v_sub_f32 v86, v86, v7
  v_sub_f32 v90, v90, v7
  v_sub_f32 v94, v94, v7
  v_exp_f32 v66, v66
  v_exp_f32 v70, v70
  v_exp_f32 v74, v74
  v_exp_f32 v78, v78
  v_exp_f32 v82, v82
  v_exp_f32 v86, v86
  v_exp_f32 v90, v90
  v_exp_f32 v94, v94
  s_nop 0
  v_mul_f32 v8, v66, v64
  v_mul_f32 v11, v66, v65
  v_mul_f32 v12, v66, v67
  v_fmac_f32 v8, v70, v68
  v_fmac_f32 v11, v70, v69
  v_fmac_f32 v12, v70, v71
  v_fmac_f32 v8, v74, v72
  v_fmac_f32 v11, v74, v73
  v_fmac_f32 v12, v74, v75
  v_fmac_f32 v8, v78, v76
  v_fmac_f32 v11, v78, v77
  v_fmac_f32 v12, v78, v79
  v_fmac_f32 v8, v82, v80
  v_fmac_f32 v11, v82, v81
  v_fmac_f32 v12, v82, v83
  v_fmac_f32 v8, v86, v84
  v_fmac_f32 v11, v86, v85
  v_fmac_f32 v12, v86, v87
  v_fmac_f32 v8, v90, v88
  v_fmac_f32 v11, v90, v89
  v_fmac_f32 v12, v90, v91
  v_fmac_f32 v8, v94, v92
  v_fmac_f32 v11, v94, v93
  v_fmac_f32 v12, v94, v95
  v_rcp_f32 v12, v12
  v_lshlrev_b32 v13, 9, v9
  v_lshl_add_u32 v13, v10, 2, v13
  v_mul_f32 v8, v8, v12
  v_mul_f32 v11, v11, v12
  v_add_u32 v13, 161024, v13
  v_cvt_pk_bf16_f32 v8, v8, v11
  ds_write_b32 v13, v8
  v_and_b32 v4, 1, v2
  v_lshlrev_b32 v4, 9, v4
  v_lshl_add_u32 v4, v3, 4, v4
  v_add_u32 v4, 161024, v4
  v_lshlrev_b32 v5, 8, v2
  v_lshl_add_u32 v5, v3, 4, v5
  s_lshl_b32 s66, s4, 1
  s_add_u32 s66, s66, s73
  s_lshl_b32 s66, s66, 9
  s_lshl_b32 s67, s74, 14
  s_add_u32 s66, s66, s67
  s_lshl_b32 s67, s3, 6
  s_add_u32 s66, s66, s67
  s_add_u32 s66, s66, 2621440
  s_waitcnt lgkmcnt(0)
  s_barrier
  ds_read_b128 v[32:35], v4 offset:0
  ds_read_b128 v[36:39], v4 offset:64
  ds_read_b128 v[40:43], v4 offset:128
  ds_read_b128 v[44:47], v4 offset:192
  ds_read_b128 v[48:51], v4 offset:256
  ds_read_b128 v[52:55], v4 offset:320
  ds_read_b128 v[56:59], v4 offset:384
  ds_read_b128 v[60:63], v4 offset:448
  s_waitcnt lgkmcnt(7)
  v_mfma_f32_16x16x32_bf16 v[64:67], v[160:163], v[32:35], 0
  s_waitcnt lgkmcnt(6)
  v_mfma_f32_16x16x32_bf16 v[64:67], v[164:167], v[36:39], v[64:67]
  s_waitcnt lgkmcnt(5)
  v_mfma_f32_16x16x32_bf16 v[64:67], v[168:171], v[40:43], v[64:67]
  s_waitcnt lgkmcnt(4)
  v_mfma_f32_16x16x32_bf16 v[64:67], v[172:175], v[44:47], v[64:67]
  s_waitcnt lgkmcnt(3)
  v_mfma_f32_16x16x32_bf16 v[64:67], v[176:179], v[48:51], v[64:67]
  s_waitcnt lgkmcnt(2)
  v_mfma_f32_16x16x32_bf16 v[64:67], v[180:183], v[52:55], v[64:67]
  s_waitcnt lgkmcnt(1)
  v_mfma_f32_16x16x32_bf16 v[64:67], v[184:187], v[56:59], v[64:67]
  s_waitcnt lgkmcnt(0)
  v_mfma_f32_16x16x32_bf16 v[64:67], v[188:191], v[60:63], v[64:67]
  s_mov_b64 exec, s[62:63]
  s_nop 7
  v_min_u32 v64, v64, v16
  v_min_u32 v65, v65, v16
  v_min_u32 v66, v66, v16
  v_min_u32 v67, v67, v16
  buffer_store_dwordx4 v[64:67], v5, s[44:47], s66 offen sc1
  s_endpgm
L_final:
  s_lshl_b32 s66, s4, 1
  s_add_u32 s66, s66, s5
  s_sub_u32 s66, s66, 14
  s_cmp_ge_u32 s66, 14
  s_cbranch_scc1 L_fin_exit
  s_lshr_b32 s74, s66, 1
  s_and_b32 s73, s66, 1
  s_mul_i32 s66, s73, 896
  s_add_u32 s52, s24, s66
  s_addc_u32 s53, s25, 0
  s_movk_i32 s54, 896
  s_mov_b32 s55, 0x00020000
  s_mov_b32 s60, s16
  s_mov_b32 s61, s17
  s_movk_i32 s62, 896
  s_mov_b32 s63, 0x00020000
  s_mov_b32 s56, s18
  s_mov_b32 s57, s19
  s_movk_i32 s58, 1792
  s_mov_b32 s59, 0x00020000
  v_lshlrev_b32 v4, 4, v1
  buffer_load_dwordx4 v[32:35], v4, s[60:63], 0 offen
  buffer_load_dwordx4 v[36:39], v4, s[52:55], 0 offen
  v_mov_b32 v6, 160832
  ds_read2_b32 v[14:15], v6 offset0:1 offset1:2
  v_lshlrev_b32 v5, 5, v1
  s_waitcnt vmcnt(0) lgkmcnt(0)
  v_mov_b32 v7, 0
  v_lshlrev_b32 v8, 16, v32
  v_lshlrev_b32 v9, 16, v36
  v_and_b32 v10, 0xffff0000, v32
  v_and_b32 v11, 0xffff0000, v36
  v_mul_f32 v8, v8, v9
  v_mul_f32 v10, v10, v11
  v_cvt_pk_bf16_f32 v8, v8, v10
  v_lshlrev_b32 v9, 16, v8
  v_and_b32 v8, 0xffff0000, v8
  v_add_f32 v7, v7, v9
  v_add_f32 v7, v7, v8
  v_lshlrev_b32 v8, 16, v33
  v_lshlrev_b32 v9, 16, v37
  v_and_b32 v10, 0xffff0000, v33
  v_and_b32 v11, 0xffff0000, v37
  v_mul_f32 v8, v8, v9
  v_mul_f32 v10, v10, v11
  v_cvt_pk_bf16_f32 v8, v8, v10
  v_lshlrev_b32 v9, 16, v8
  v_and_b32 v8, 0xffff0000, v8
  v_add_f32 v7, v7, v9
  v_add_f32 v7, v7, v8
  v_lshlrev_b32 v8, 16, v34
  v_lshlrev_b32 v9, 16, v38
  v_and_b32 v10, 0xffff0000, v34
  v_and_b32 v11, 0xffff0000, v38
  v_mul_f32 v8, v8, v9
  v_mul_f32 v10, v10, v11
  v_cvt_pk_bf16_f32 v8, v8, v10
  v_lshlrev_b32 v9, 16, v8
  v_and_b32 v8, 0xffff0000, v8
  v_add_f32 v7, v7, v9
  v_add_f32 v7, v7, v8
  v_lshlrev_b32 v8, 16, v35
  v_lshlrev_b32 v9, 16, v39
  v_and_b32 v10, 0xffff0000, v35
  v_and_b32 v11, 0xffff0000, v39
  v_mul_f32 v8, v8, v9
  v_mul_f32 v10, v10, v11
  v_cvt_pk_bf16_f32 v8, v8, v10
  v_lshlrev_b32 v9, 16, v8
  v_and_b32 v8, 0xffff0000, v8
  v_add_f32 v7, v7, v9
  v_add_f32 v7, v7, v8
  v_lshlrev_b32 v8, 2, v1
  v_xor_b32 v9, 4, v8
  ds_bpermute_b32 v10, v9, v7
  s_waitcnt lgkmcnt(0)
  v_add_f32 v7, v7, v10
  v_xor_b32 v9, 8, v8
  ds_bpermute_b32 v10, v9, v7
  s_waitcnt lgkmcnt(0)
  v_add_f32 v7, v7, v10
  v_xor_b32 v9, 16, v8
  ds_bpermute_b32 v10, v9, v7
  s_waitcnt lgkmcnt(0)
  v_add_f32 v7, v7, v10
  v_xor_b32 v9, 32, v8
  ds_bpermute_b32 v10, v9, v7
  s_waitcnt lgkmcnt(0)
  v_add_f32 v7, v7, v10
  v_xor_b32 v9, 64, v8
  ds_bpermute_b32 v10, v9, v7
  s_waitcnt lgkmcnt(0)
  v_add_f32 v7, v7, v10
  v_xor_b32 v9, 128, v8
  ds_bpermute_b32 v10, v9, v7
  s_waitcnt lgkmcnt(0)
  v_add_f32 v7, v7, v10
  v_cvt_pk_bf16_f32 v7, v7, v7
  v_lshlrev_b32 v7, 16, v7
  v_mul_f32 v8, 3216550459, v7
  v_exp_f32 v8, v8
  s_nop 0
  v_add_f32 v8, 1.0, v8
  v_rcp_f32 v8, v8
  s_nop 0
  v_cvt_pk_bf16_f32 v8, v8, v8
  v_lshlrev_b32 v30, 16, v8
  v_sub_f32 v9, 1.0, v30
  v_cvt_pk_bf16_f32 v9, v9, v9
  v_lshlrev_b32 v31, 16, v9
  s_mov_b32 s71, 0
L_fflag:
  s_movk_i32 s66, 4096
  buffer_load_dwordx4 v[32:35], v5, s[44:47], s66 offen sc1
  buffer_load_dwordx4 v[36:39], v5, s[44:47], s66 offen offset:16 sc1
  s_waitcnt vmcnt(0)
  v_xor_b32 v6, v33, v14
  v_xor_b32 v7, v35, v14
  v_xor_b32 v8, v37, v14
  v_xor_b32 v9, v39, v14
  v_or_b32 v6, v6, v7
  v_or3_b32 v6, v6, v8, v9
  v_cmp_ne_u32 vcc, 0, v6
  s_cmp_eq_u64 vcc, 0
  s_cbranch_scc1 L_fflag_ok
  s_add_u32 s71, s71, 1
  s_cmp_lt_u32 s71, 40000
  s_cbranch_scc1 L_fflag
L_fflag_ok:
  v_lshlrev_b32 v4, 9, v3
  v_lshl_add_u32 v4, v2, 2, v4
  s_lshl_b32 s66, s74, 14
  s_lshl_b32 s67, s73, 8
  s_add_u32 s66, s66, s67
  s_lshl_b32 s67, s3, 6
  s_add_u32 s66, s66, s67
  s_add_u32 s66, s66, 2621440
  s_mul_i32 s68, s73, 896
  s_lshl_b32 s67, s74, 7
  s_add_u32 s68, s68, s67
  s_lshl_b32 s67, s3, 5
  s_add_u32 s68, s68, s67
  v_lshlrev_b32 v5, 1, v2
  v_lshlrev_b32 v9, 2, v1
  v_xor_b32 v10, 64, v9
  v_xor_b32 v12, 128, v9
  v_cmp_gt_u32 s[62:63], 16, v1
  s_mov_b32 s70, 0xff
  s_mov_b32 s71, 0
L_h2poll:
  s_bitcmp1_b32 s70, 0
  s_cbranch_scc0 L_h2skip0
  s_add_u32 s67, s66, 0
  buffer_load_dword v64, v4, s[44:47], s67 offen sc1
L_h2skip0:
  s_bitcmp1_b32 s70, 1
  s_cbranch_scc0 L_h2skip1
  s_add_u32 s67, s66, 2048
  buffer_load_dword v65, v4, s[44:47], s67 offen sc1
L_h2skip1:
  s_bitcmp1_b32 s70, 2
  s_cbranch_scc0 L_h2skip2
  s_add_u32 s67, s66, 4096
  buffer_load_dword v66, v4, s[44:47], s67 offen sc1
L_h2skip2:
  s_bitcmp1_b32 s70, 3
  s_cbranch_scc0 L_h2skip3
  s_add_u32 s67, s66, 6144
  buffer_load_dword v67, v4, s[44:47], s67 offen sc1
L_h2skip3:
  s_bitcmp1_b32 s70, 4
  s_cbranch_scc0 L_h2skip4
  s_add_u32 s67, s66, 8192
  buffer_load_dword v68, v4, s[44:47], s67 offen sc1
L_h2skip4:
  s_bitcmp1_b32 s70, 5
  s_cbranch_scc0 L_h2skip5
  s_add_u32 s67, s66, 10240
  buffer_load_dword v69, v4, s[44:47], s67 offen sc1
L_h2skip5:
  s_bitcmp1_b32 s70, 6
  s_cbranch_scc0 L_h2skip6
  s_add_u32 s67, s66, 12288
  buffer_load_dword v70, v4, s[44:47], s67 offen sc1
L_h2skip6:
  s_bitcmp1_b32 s70, 7
  s_cbranch_scc0 L_h2skip7
  s_add_u32 s67, s66, 14336
  buffer_load_dword v71, v4, s[44:47], s67 offen sc1
L_h2skip7:
  s_waitcnt vmcnt(0)
  s_bitcmp1_b32 s70, 0
  s_cbranch_scc0 L_h2chk0
  v_cmp_eq_u32 vcc, -1, v64
  s_cmp_eq_u64 vcc, 0
  s_cbranch_scc0 L_h2chk0
  s_bitset0_b32 s70, 0
L_h2chk0:
  s_bitcmp1_b32 s70, 1
  s_cbranch_scc0 L_h2chk1
  v_cmp_eq_u32 vcc, -1, v65
  s_cmp_eq_u64 vcc, 0
  s_cbranch_scc0 L_h2chk1
  s_bitset0_b32 s70, 1
L_h2chk1:
  s_bitcmp1_b32 s70, 2
  s_cbranch_scc0 L_h2chk2
  v_cmp_eq_u32 vcc, -1, v66
  s_cmp_eq_u64 vcc, 0
  s_cbranch_scc0 L_h2chk2
  s_bitset0_b32 s70, 2
L_h2chk2:
  s_bitcmp1_b32 s70, 3
  s_cbranch_scc0 L_h2chk3
  v_cmp_eq_u32 vcc, -1, v67
  s_cmp_eq_u64 vcc, 0
  s_cbranch_scc0 L_h2chk3
  s_bitset0_b32 s70, 3
L_h2chk3:
  s_bitcmp1_b32 s70, 4
  s_cbranch_scc0 L_h2chk4
  v_cmp_eq_u32 vcc, -1, v68
  s_cmp_eq_u64 vcc, 0
  s_cbranch_scc0 L_h2chk4
  s_bitset0_b32 s70, 4
L_h2chk4:
  s_bitcmp1_b32 s70, 5
  s_cbranch_scc0 L_h2chk5
  v_cmp_eq_u32 vcc, -1, v69
  s_cmp_eq_u64 vcc, 0
  s_cbranch_scc0 L_h2chk5
  s_bitset0_b32 s70, 5
L_h2chk5:
  s_bitcmp1_b32 s70, 6
  s_cbranch_scc0 L_h2chk6
  v_cmp_eq_u32 vcc, -1, v70
  s_cmp_eq_u64 vcc, 0
  s_cbranch_scc0 L_h2chk6
  s_bitset0_b32 s70, 6
L_h2chk6:
  s_bitcmp1_b32 s70, 7
  s_cbranch_scc0 L_h2chk7
  v_cmp_eq_u32 vcc, -1, v71
  s_cmp_eq_u64 vcc, 0
  s_cbranch_scc0 L_h2chk7
  s_bitset0_b32 s70, 7
L_h2chk7:
  s_cmp_eq_u32 s70, 0
  s_cbranch_scc1 L_h2done
  s_add_u32 s71, s71, 1
  s_cmp_lt_u32 s71, 40000
  s_cbranch_scc1 L_h2poll
L_h2done:
  v_add_f32 v8, v64, v65
  v_add_f32 v7, v66, v67
  v_add_f32 v13, v68, v69
  v_add_f32 v11, v70, v71
  v_add_f32 v8, v8, v7
  v_add_f32 v13, v13, v11
  v_mul_f32 v8, v8, v30
  v_fmac_f32 v8, v13, v31
  ds_bpermute_b32 v11, v10, v8
  s_waitcnt lgkmcnt(0)
  v_add_f32 v8, v8, v11
  ds_bpermute_b32 v11, v12, v8
  s_waitcnt lgkmcnt(0)
  v_add_f32 v8, v8, v11
  v_cvt_pk_bf16_f32 v8, v8, v8
  s_mov_b64 exec, s[62:63]
  buffer_store_short v8, v5, s[56:59], s68 offen
  s_or_b32 s66, s73, s74
  s_or_b32 s66, s66, s3
  s_cmp_lg_u32 s66, 0
  s_cbranch_scc1 L_nobump
  v_add_u32 v15, 1, v15
  v_mov_b32 v5, 0
  buffer_store_dword v15, v5, s[44:47], 0 offen
L_nobump:
L_fin_exit:
  s_endpgm
L_helper:
  s_setprio 3
  v_lshrrev_b32 v4, 2, v1
  v_and_b32 v5, 3, v1
  v_lshrrev_b32 v6, 5, v1
  v_lshlrev_b32 v6, 1, v6
  v_xor_b32 v5, v5, v6
  v_lshlrev_b32 v5, 4, v5
  v_lshl_add_u32 v28, v4, 13, v5
  s_lshl_b32 s67, s7, 10
  s_lshl_b32 s68, s5, 6
  s_add_u32 s67, s67, s68
  v_and_b32 v4, 1, v2
  s_movk_i32 s66, 896
  v_mul_lo_u32 v4, v4, s66
  v_lshl_add_u32 v4, v3, 4, v4
  v_mov_b32 v7, 0
  v_mov_b32 v8, 160832
  v_mov_b32 v9, 0
  ds_write_b32 v8, v9 offset:12
  v_lshlrev_b32 v5, 4, v1
  s_lshl_b32 s68, s4, 1
  s_add_u32 s68, s68, s26
  s_lshl_b32 s68, s68, 3
  s_add_u32 s68, s68, s27
  s_lshl_b32 s68, s68, 12
  s_add_u32 s70, s68, 1572864
  s_add_u32 s68, s68, 524288
  s_lshl_b32 s69, s4, 1
  s_add_u32 s69, s69, s73
  s_lshl_b32 s69, s69, 9
  s_lshl_b32 s71, s74, 14
  s_add_u32 s69, s69, s71
  s_add_u32 s69, s69, 2621440
  s_cmp_lt_u32 s5, 14
  s_cselect_b32 s69, s69, 0x40000000
  v_mov_b32 v8, -1
  v_mov_b32 v9, -1
  v_mov_b32 v10, -1
  v_mov_b32 v11, -1
  v_cmp_gt_u32 s[62:63], 32, v1
  s_waitcnt lgkmcnt(0)
  s_mov_b32 s36, s12
  s_mov_b32 s37, s13
  s_mov_b32 s38, 3670016
  s_mov_b32 s39, 0x00020000
  s_mov_b32 m0, 131072
  s_mov_b32 s44, s22
  s_mov_b32 s45, s23
  s_mov_b32 s46, 2883584
  s_mov_b32 s47, 0x00020000
  buffer_load_dword v26, v7, s[44:47], 0 offen
  s_mov_b32 s52, s24
  s_mov_b32 s53, s25
  s_movk_i32 s54, 1792
  s_mov_b32 s55, 0x00020000
  buffer_load_dwordx4 v[128:131], v4, s[52:55], 0 offen offset:0
  buffer_load_dwordx4 v[132:135], v4, s[52:55], 0 offen offset:64
  buffer_load_dwordx4 v[136:139], v4, s[52:55], 0 offen offset:128
  buffer_load_dwordx4 v[140:143], v4, s[52:55], 0 offen offset:192
  buffer_load_dwordx4 v[144:147], v4, s[52:55], 0 offen offset:256
  buffer_load_dwordx4 v[148:151], v4, s[52:55], 0 offen offset:320
  buffer_load_dwordx4 v[152:155], v4, s[52:55], 0 offen offset:384
  buffer_load_dwordx4 v[156:159], v4, s[52:55], 0 offen offset:448
  buffer_load_dwordx4 v[160:163], v4, s[52:55], 0 offen offset:512
  buffer_load_dwordx4 v[164:167], v4, s[52:55], 0 offen offset:576
  buffer_load_dwordx4 v[168:171], v4, s[52:55], 0 offen offset:640
  buffer_load_dwordx4 v[172:175], v4, s[52:55], 0 offen offset:704
  buffer_load_dwordx4 v[176:179], v4, s[52:55], 0 offen offset:768
  buffer_load_dwordx4 v[180:183], v4, s[52:55], 0 offen offset:832
  buffer_store_dwordx4 v[8:11], v5, s[44:47], s68 offen offset:0 sc1
  buffer_store_dwordx4 v[8:11], v5, s[44:47], s68 offen offset:1024 sc1
  buffer_store_dwordx4 v[8:11], v5, s[44:47], s68 offen offset:2048 sc1
  buffer_store_dwordx4 v[8:11], v5, s[44:47], s68 offen offset:3072 sc1
  buffer_store_dwordx4 v[8:11], v5, s[44:47], s70 offen offset:0 sc1
  buffer_store_dwordx4 v[8:11], v5, s[44:47], s70 offen offset:1024 sc1
  buffer_store_dwordx4 v[8:11], v5, s[44:47], s70 offen offset:2048 sc1
  buffer_store_dwordx4 v[8:11], v5, s[44:47], s70 offen offset:3072 sc1
  s_mov_b64 exec, s[62:63]
  buffer_store_dwordx4 v[8:11], v5, s[44:47], s69 offen sc1
  s_mov_b64 exec, -1
  v_bfe_u32 v12, v1, 2, 2
  v_lshl_add_u32 v12, v3, 3, v12
  v_and_b32 v13, 3, v1
  v_lshlrev_b32 v13, 3, v13
  v_lshl_add_u32 v13, v12, 6, v13
  v_add_u32 v13, 131072, v13
  v_and_b32 v14, 1, v3
  v_xor_b32 v6, 0, v14
  v_lshl_add_u32 v16, v6, 5, v13
  v_xor_b32 v6, 1, v14
  v_lshl_add_u32 v17, v6, 5, v13
  v_and_b32 v6, 1, v2
  v_lshlrev_b32 v6, 11, v6
  v_lshrrev_b32 v7, 1, v2
  v_lshl_add_u32 v6, v7, 6, v6
  v_lshl_add_u32 v6, v3, 4, v6
  v_cmp_eq_u32 s[56:57], 1, v7
  v_cmp_gt_u32 s[58:59], 4, v2
  s_lshl_b32 s66, s4, 12
  s_lshl_b32 s67, s5, 7
  s_add_u32 s66, s66, s67
  s_add_u32 s66, s66, 262144
  s_getreg_b32 s72, hwreg(HW_REG_XCC_ID)
  s_and_b32 s72, s72, 15
  v_lshlrev_b32 v24, 4, v1
  s_lshl_b32 s68, s4, 12
  s_lshl_b32 s67, s26, 11
  s_add_u32 s68, s68, s67
  s_add_u32 s68, s68, 262144
  s_lshl_b32 s67, s4, 4
  s_add_u32 s67, s67, s5
  s_lshl_b32 s67, s67, 3
  s_add_u32 s67, s67, 4096
  v_mov_b32 v28, s72
  v_mov_b32 v7, 0
  v_cmp_eq_u32 s[62:63], 0, v1
  v_lshlrev_b32 v25, 3, v1
  v_add_u32 v25, 0, v25
  s_waitcnt vmcnt(9)
  s_barrier
  s_mov_b32 s69, 0x9E3779B1
  v_mul_lo_u32 v27, v26, s69
  v_add_u32 v27, 0x7F4A7C15, v27
  v_mov_b32 v29, v27
  ds_read_b64_tr_b16 v[32:33], v16 offset:0
  ds_read_b64_tr_b16 v[34:35], v16 offset:256
  ds_read_b64_tr_b16 v[36:37], v17 offset:0
  ds_read_b64_tr_b16 v[38:39], v17 offset:256
  ds_read_b64_tr_b16 v[40:41], v16 offset:2048
  ds_read_b64_tr_b16 v[42:43], v16 offset:2304
  ds_read_b64_tr_b16 v[44:45], v17 offset:2048
  ds_read_b64_tr_b16 v[46:47], v17 offset:2304
  ds_read_b64_tr_b16 v[48:49], v16 offset:4096
  ds_read_b64_tr_b16 v[50:51], v16 offset:4352
  ds_read_b64_tr_b16 v[52:53], v17 offset:4096
  ds_read_b64_tr_b16 v[54:55], v17 offset:4352
  s_waitcnt lgkmcnt(8)
  v_mfma_f32_16x16x32_bf16 v[184:187], v[32:35], v[128:131], 0
  v_mfma_f32_16x16x32_bf16 v[188:191], v[36:39], v[128:131], 0
  ds_read_b64_tr_b16 v[56:57], v16 offset:6144
  ds_read_b64_tr_b16 v[58:59], v16 offset:6400
  ds_read_b64_tr_b16 v[60:61], v17 offset:6144
  ds_read_b64_tr_b16 v[62:63], v17 offset:6400
  s_waitcnt lgkmcnt(8)
  v_mfma_f32_16x16x32_bf16 v[184:187], v[40:43], v[132:135], v[184:187]
  v_mfma_f32_16x16x32_bf16 v[188:191], v[44:47], v[132:135], v[188:191]
  ds_read_b64_tr_b16 v[32:33], v16 offset:8192
  ds_read_b64_tr_b16 v[34:35], v16 offset:8448
  ds_read_b64_tr_b16 v[36:37], v17 offset:8192
  ds_read_b64_tr_b16 v[38:39], v17 offset:8448
  s_waitcnt lgkmcnt(8)
  v_mfma_f32_16x16x32_bf16 v[184:187], v[48:51], v[136:139], v[184:187]
  v_mfma_f32_16x16x32_bf16 v[188:191], v[52:55], v[136:139], v[188:191]
  ds_read_b64_tr_b16 v[40:41], v16 offset:10240
  ds_read_b64_tr_b16 v[42:43], v16 offset:10496
  ds_read_b64_tr_b16 v[44:45], v17 offset:10240
  ds_read_b64_tr_b16 v[46:47], v17 offset:10496
  s_waitcnt lgkmcnt(8)
  v_mfma_f32_16x16x32_bf16 v[184:187], v[56:59], v[140:143], v[184:187]
  v_mfma_f32_16x16x32_bf16 v[188:191], v[60:63], v[140:143], v[188:191]
  ds_read_b64_tr_b16 v[48:49], v16 offset:12288
  ds_read_b64_tr_b16 v[50:51], v16 offset:12544
  ds_read_b64_tr_b16 v[52:53], v17 offset:12288
  ds_read_b64_tr_b16 v[54:55], v17 offset:12544
  s_waitcnt lgkmcnt(8)
  v_mfma_f32_16x16x32_bf16 v[184:187], v[32:35], v[144:147], v[184:187]
  v_mfma_f32_16x16x32_bf16 v[188:191], v[36:39], v[144:147], v[188:191]
  ds_read_b64_tr_b16 v[56:57], v16 offset:14336
  ds_read_b64_tr_b16 v[58:59], v16 offset:14592
  ds_read_b64_tr_b16 v[60:61], v17 offset:14336
  ds_read_b64_tr_b16 v[62:63], v17 offset:14592
  s_waitcnt lgkmcnt(8)
  v_mfma_f32_16x16x32_bf16 v[184:187], v[40:43], v[148:151], v[184:187]
  v_mfma_f32_16x16x32_bf16 v[188:191], v[44:47], v[148:151], v[188:191]
  ds_read_b64_tr_b16 v[32:33], v16 offset:16384
  ds_read_b64_tr_b16 v[34:35], v16 offset:16640
  ds_read_b64_tr_b16 v[36:37], v17 offset:16384
  ds_read_b64_tr_b16 v[38:39], v17 offset:16640
  s_waitcnt lgkmcnt(8)
  v_mfma_f32_16x16x32_bf16 v[184:187], v[48:51], v[152:155], v[184:187]
  v_mfma_f32_16x16x32_bf16 v[188:191], v[52:55], v[152:155], v[188:191]
  ds_read_b64_tr_b16 v[40:41], v16 offset:18432
  ds_read_b64_tr_b16 v[42:43], v16 offset:18688
  ds_read_b64_tr_b16 v[44:45], v17 offset:18432
  ds_read_b64_tr_b16 v[46:47], v17 offset:18688
  s_waitcnt lgkmcnt(8)
  v_mfma_f32_16x16x32_bf16 v[184:187], v[56:59], v[156:159], v[184:187]
  v_mfma_f32_16x16x32_bf16 v[188:191], v[60:63], v[156:159], v[188:191]
  ds_read_b64_tr_b16 v[48:49], v16 offset:20480
  ds_read_b64_tr_b16 v[50:51], v16 offset:20736
  ds_read_b64_tr_b16 v[52:53], v17 offset:20480
  ds_read_b64_tr_b16 v[54:55], v17 offset:20736
  s_waitcnt lgkmcnt(8)
  v_mfma_f32_16x16x32_bf16 v[184:187], v[32:35], v[160:163], v[184:187]
  v_mfma_f32_16x16x32_bf16 v[188:191], v[36:39], v[160:163], v[188:191]
  ds_read_b64_tr_b16 v[56:57], v16 offset:22528
  ds_read_b64_tr_b16 v[58:59], v16 offset:22784
  ds_read_b64_tr_b16 v[60:61], v17 offset:22528
  ds_read_b64_tr_b16 v[62:63], v17 offset:22784
  s_waitcnt lgkmcnt(8)
  v_mfma_f32_16x16x32_bf16 v[184:187], v[40:43], v[164:167], v[184:187]
  v_mfma_f32_16x16x32_bf16 v[188:191], v[44:47], v[164:167], v[188:191]
  ds_read_b64_tr_b16 v[32:33], v16 offset:24576
  ds_read_b64_tr_b16 v[34:35], v16 offset:24832
  ds_read_b64_tr_b16 v[36:37], v17 offset:24576
  ds_read_b64_tr_b16 v[38:39], v17 offset:24832
  s_waitcnt lgkmcnt(8)
  v_mfma_f32_16x16x32_bf16 v[184:187], v[48:51], v[168:171], v[184:187]
  v_mfma_f32_16x16x32_bf16 v[188:191], v[52:55], v[168:171], v[188:191]
  ds_read_b64_tr_b16 v[40:41], v16 offset:26624
  ds_read_b64_tr_b16 v[42:43], v16 offset:26880
  ds_read_b64_tr_b16 v[44:45], v17 offset:26624
  ds_read_b64_tr_b16 v[46:47], v17 offset:26880
  s_waitcnt lgkmcnt(8)
  v_mfma_f32_16x16x32_bf16 v[184:187], v[56:59], v[172:175], v[184:187]
  v_mfma_f32_16x16x32_bf16 v[188:191], v[60:63], v[172:175], v[188:191]
  s_waitcnt lgkmcnt(4)
  v_mfma_f32_16x16x32_bf16 v[184:187], v[32:35], v[176:179], v[184:187]
  v_mfma_f32_16x16x32_bf16 v[188:191], v[36:39], v[176:179], v[188:191]
  s_waitcnt lgkmcnt(0)
  v_mfma_f32_16x16x32_bf16 v[184:187], v[40:43], v[180:183], v[184:187]
  v_mfma_f32_16x16x32_bf16 v[188:191], v[44:47], v[180:183], v[188:191]
  s_waitcnt vmcnt(0)
  s_nop 7
  v_cvt_pk_bf16_f32 v32, v184, v185
  v_cvt_pk_bf16_f32 v33, v186, v187
  v_cvt_pk_bf16_f32 v34, v188, v189
  v_cvt_pk_bf16_f32 v35, v190, v191
  v_mov_b32 v45, v27
  v_mov_b32 v47, v27
  v_cndmask_b32 v44, v32, v34, s[56:57]
  v_cndmask_b32 v46, v33, v35, s[56:57]
  s_add_u32 s69, s66, 131072
  s_add_u32 s70, s67, 4096
  s_mov_b64 exec, s[58:59]
  buffer_store_dwordx4 v[44:47], v6, s[44:47], s69 offen
  s_mov_b64 exec, s[62:63]
  buffer_store_dwordx2 v[28:29], v7, s[44:47], s70 offen
  s_mov_b64 exec, -1
  s_lshl_b32 s74, s4, 7
  s_add_u32 s74, s74, 4096
  v_cmp_gt_u32 s[60:61], 16, v1
  s_mov_b32 s71, 0
  s_mov_b32 s73, 0
L_qpoll:
  s_cmp_lt_u32 s71, 2
  s_cselect_b32 s69, 131072, 0
  s_cselect_b32 s70, 4096, 0
  s_add_u32 s69, s69, s68
  s_add_u32 s70, s70, s74
  buffer_load_dwordx4 v[64:67], v24, s[44:47], s69 offen sc1
  buffer_load_dwordx4 v[68:71], v24, s[44:47], s69 offen offset:1024 sc1
  s_mov_b64 exec, s[60:61]
  buffer_load_dwordx2 v[30:31], v25, s[44:47], s70 offen sc1
  s_mov_b64 exec, -1
  v_mov_b32 v73, 0
  s_cmp_lg_u32 s73, 0
  s_cbranch_scc1 L_qw0
  s_mov_b32 s73, 1
  s_mov_b64 exec, s[58:59]
  buffer_store_dwordx4 v[44:47], v6, s[44:47], s66 offen sc1
  s_mov_b64 exec, s[62:63]
  buffer_store_dwordx2 v[28:29], v7, s[44:47], s67 offen sc1
  s_mov_b64 exec, -1
  s_waitcnt vmcnt(2)
  s_branch L_qw1
L_qw0:
  s_waitcnt vmcnt(0)
L_qw1:
  v_xor_b32 v72, v65, v27
  s_mov_b64 exec, s[60:61]
  v_xor_b32 v73, v31, v27
  s_mov_b64 exec, -1
  v_xor_b32 v74, v67, v27
  v_or3_b32 v72, v72, v73, v74
  v_xor_b32 v74, v69, v27
  v_xor_b32 v75, v71, v27
  v_or3_b32 v72, v72, v74, v75
  v_cmp_ne_u32 vcc, 0, v72
  s_cmp_eq_u64 vcc, 0
  s_cbranch_scc1 L_qready
  s_add_u32 s71, s71, 1
  s_cmp_lt_u32 s71, 40000
  s_cbranch_scc1 L_qpoll
L_qready:
  v_mov_b32 v65, v66
  v_mov_b32 v69, v70
  v_lshlrev_b32 v9, 3, v1
  v_add_u32 v9, 159744, v9
  ds_write_b64 v9, v[64:65]
  ds_write_b64 v9, v[68:69] offset:512
  s_mov_b64 exec, s[60:61]
  v_cmp_eq_u32 vcc, s72, v30
  s_mov_b64 exec, -1
  s_nop 1
  v_mov_b32 v8, vcc_lo
  v_mov_b32 v9, v27
  v_mov_b32 v10, v26
  v_mov_b32 v11, 1
  v_mov_b32 v12, 160832
  s_waitcnt lgkmcnt(0)
  ds_write_b128 v12, v[8:11]
  s_waitcnt lgkmcnt(0)
  s_cmp_lg_u32 s73, 0
  s_cbranch_scc1 L_qBd
  s_mov_b64 exec, s[58:59]
  buffer_store_dwordx4 v[44:47], v6, s[44:47], s66 offen sc1
  s_mov_b64 exec, s[62:63]
  buffer_store_dwordx2 v[28:29], v7, s[44:47], s67 offen sc1
  s_mov_b64 exec, -1
L_qBd:
  s_barrier
  s_barrier
  s_endpgm
L_end:
  s_endpgm
.section .rodata,"a"
.p2align 6
.amdhsa_kernel gated_mix__gqa_block_cached__gqa_block_cached__decode_kernel
  .amdhsa_next_free_vgpr 256
  .amdhsa_next_free_sgpr 102
  .amdhsa_accum_offset 256
  .amdhsa_group_segment_fixed_size 0
  .amdhsa_kernarg_size 112
  .amdhsa_user_sgpr_count 2
  .amdhsa_user_sgpr_kernarg_segment_ptr 1
  .amdhsa_system_sgpr_workgroup_id_x 1
.end_amdhsa_kernel
```
